```python
import torch

def _softmax(x, axis=-1):
    return torch.softmax(x, dim=axis)

def _gelu(x):
    return torch.nn.functional.gelu(x, approximate='tanh')

def _silu(x):
    return torch.nn.functional.silu(x)

def _sigmoid(x):
    return torch.sigmoid(x)

def _layernorm(x, axis=-1, eps=1e-05):
    m = x.mean(dim=axis, keepdim=True)
    v = x.var(dim=axis, keepdim=True, unbiased=False)
    return (x - m) / torch.sqrt(v + eps)

def _scatter_add(tgt, idx, src, axis=0):
    return tgt.clone().index_add_(axis, idx, src)

def _segment_sum(src, seg, n):
    out = torch.zeros((n,) + src.shape[1:], dtype=src.dtype)
    return out.index_add_(0, seg, src)

def _pad(x, pw):
    flat = tuple((v for pair in reversed(pw) for v in pair))
    return torch.nn.functional.pad(x, flat)
kernel_name = 'adaLN_cond__ssm_conv_s4d__geglu_ffn__prompt'

def setup_inputs():

    _w = lambda a: (lambda t: t.to(torch.bfloat16) if t.is_floating_point() else t)(torch.as_tensor(a))

    def _A_setup():
        Bsz, L, D, N = (1, 2048, 640, 128)
        return {'u': _w((lambda *s: torch.randn(*s, dtype=torch.bfloat16) * 0.05)(Bsz, L, D)), 'log_A_real': _w((lambda *s: torch.randn(*s, dtype=torch.bfloat16) * 3.2)(D, N) * 0.5), 'A_imag': _w((lambda *s: torch.randn(*s, dtype=torch.bfloat16) * 0.1)(D, N) * 3.14), 'C_real': _w((lambda *s: torch.randn(*s, dtype=torch.bfloat16) * 0.4)(D, N) / N ** 0.5), 'C_imag': _w((lambda *s: torch.randn(*s, dtype=torch.bfloat16) * 0.4)(D, N) / N ** 0.5), 'log_dt': _w((lambda *s: torch.randn(*s, dtype=torch.bfloat16) * 0.1)(D) * 0.5 - 4.0), 'D_skip': _w((lambda *s: torch.randn(*s, dtype=torch.bfloat16) * 0.1)(D))}
    _A_in = _A_setup()

    def _B_setup():
        B, S, D, F = (1, 2048, 640, 1728)
        return {'x': _w((lambda *s: torch.randn(*s, dtype=torch.bfloat16) * 0.05)(B, S, D)), 'w_gate': _w((lambda *s: torch.randn(*s, dtype=torch.bfloat16) * 0.05)(D, F)), 'w_up': _w((lambda *s: torch.randn(*s, dtype=torch.bfloat16) * 0.05)(D, F)), 'w_down': _w((lambda *s: torch.randn(*s, dtype=torch.bfloat16) * 0.05)(F, D))}
    _B_in = _B_setup()
    return {'A_u': _A_in['u'], 'A_log_A_real': _A_in['log_A_real'], 'A_A_imag': _A_in['A_imag'], 'A_C_real': _A_in['C_real'], 'A_C_imag': _A_in['C_imag'], 'A_log_dt': _A_in['log_dt'], 'A_D_skip': _A_in['D_skip'], 'B_x': _B_in['x'], 'B_w_gate': _B_in['w_gate'], 'B_w_up': _B_in['w_up'], 'B_w_down': _B_in['w_down'], 'c': _w((lambda *s: torch.randn(*s, dtype=torch.bfloat16) * 0.1)(1, 640) * 8.0), 'w_mod': _w((lambda *s: torch.randn(*s, dtype=torch.bfloat16) * 0.1)(640, 6 * 640) * 640 ** (-0.5) * 8.0)}

def reference(A_u, A_log_A_real, A_A_imag, A_C_real, A_C_imag, A_log_dt, A_D_skip, B_x, B_w_gate, B_w_up, B_w_down, c, w_mod):

    def _A_ref(u, log_A_real, A_imag, C_real, C_imag, log_dt, D_skip):
        L = u.shape[1]
        dt = torch.exp(log_dt)
        A = -torch.exp(log_A_real) + 1j * A_imag
        C = (C_real + 1j * C_imag) * dt[:, None]
        pos = (lambda x, dt: x.to(dt))(torch.arange(L), log_dt.dtype)
        P = torch.exp((A * dt[:, None])[:, :, None] * pos[None, None, :])
        K = 2.0 * torch.einsum('dn,dnl->dl', C, P).real
        L2 = 2 * L
        u_t = (lambda x, *d: x.permute(*d))(u, 0, 2, 1)
        Kf = (lambda x, *a, **k: torch.fft.rfft(x.float(), *a, **k))(K, L2)
        Uf = (lambda x, *a, **k: torch.fft.rfft(x.float(), *a, **k))(u_t, L2)
        y = (lambda x, *a, **k: torch.fft.irfft(x, *a, **k).to(torch.bfloat16))(Uf * Kf[None, :, :], L2)[:, :, :L]
        y = (lambda x, *d: x.permute(*d))(y, 0, 2, 1)
        return y + u * D_skip[None, None, :]

    def _B_ref(x, w_gate, w_up, w_down):
        return _gelu(x @ w_gate) * (x @ w_up) @ w_down
    x = A_u
    mod = (_silu(c) @ w_mod).reshape(c.shape[0], 6, 1, -1)
    sa, ca, ga, sb, cb, gb = (mod[:, 0].clone(), mod[:, 1].clone(), mod[:, 2].clone(), mod[:, 3].clone(), mod[:, 4].clone(), mod[:, 5].clone())
    h = _layernorm(x, axis=-1) * (1 + ca) + sa
    x = x + ga * _A_ref(h, A_log_A_real, A_A_imag, A_C_real, A_C_imag, A_log_dt, A_D_skip)
    h = _layernorm(x, axis=-1) * (1 + cb) + sb
    x = x + gb * _B_ref(h, B_w_gate, B_w_up, B_w_down)
    return x
```

```asm
; @launch grid=(256,1,1) block=(512,1,1) lds=163840
.amdgcn_target "amdgcn-amd-amdhsa--gfx950"
.text
.globl adaLN_cond__ssm_conv_s4d__geglu_ffn__prompt_kernel
.p2align 8
.type adaLN_cond__ssm_conv_s4d__geglu_ffn__prompt_kernel,@function
adaLN_cond__ssm_conv_s4d__geglu_ffn__prompt_kernel:
  s_cmp_ge_u32 s2, 256
  s_cbranch_scc1 L_end
  s_load_dwordx16 s[4:19], s[0:1], 0
  s_load_dwordx16 s[20:35], s[0:1], 64
  s_getpc_b64 s[38:39]
L_pc:
  v_lshrrev_b32 v1, 6, v0
  v_and_b32 v0, 63, v0
  v_readfirstlane_b32 s36, v1
  s_mov_b32 s79, 0
  s_lshr_b32 s3, s2, 3
  s_and_b32 s3, s3, 7
  s_cmp_eq_u32 s36, 0
  s_cselect_b32 s56, 0, s3
  s_cmp_eq_u32 s36, s56
  s_cbranch_scc0 L_pf_1
  s_lshl_b32 s3, s36, 13
  v_lshlrev_b32 v82, 7, v0
  v_add_u32 v82, s3, v82
  v_min_u32 v82, L_end-L_pc, v82
  global_load_dword v83, v82, s[38:39]
L_pf_1:
  s_lshl_b32 s3, s2, 3
  s_add_u32 s3, s3, s36
  s_mul_i32 s3, s3, 1280
  v_lshl_add_u32 v2, v0, 4, s3
  v_lshl_add_u32 v3, v0, 2, s3
  s_sub_u32 s37, s2, 40
  s_and_b32 s53, s2, 7
  s_lshr_b32 s91, s37, 3
  s_mul_i32 s3, s53, 27
  s_add_u32 s3, s3, s91
  s_lshr_b32 s54, s3, 3
  s_and_b32 s92, s3, 7
  s_mul_i32 s3, s3, 3
  s_min_u32 s52, s3, 637
  s_min_u32 s55, s36, 5
  s_lshl_b32 s56, s52, 1
  s_add_u32 s56, s56, s55
  s_lshl_b32 s56, s56, 7
  v_lshl_add_u32 v18, v0, 1, s56
  s_lshr_b32 s55, s55, 1
  s_add_u32 s55, s55, s52
  s_lshl_b32 s55, s55, 1
  v_mov_b32 v19, s55
  v_min_u32 v17, 2, v0
  v_add_u32 v17, s52, v17
  v_lshlrev_b32 v17, 1, v17
  s_waitcnt lgkmcnt(0)
  global_load_dwordx4 v[92:95], v2, s[4:5] nt
  global_load_dword v91, v3, s[4:5] offset:1024 nt
  s_load_dword s93, s[34:35], 139264
  s_lshl_b32 s68, s2, 1
  s_and_b32 s55, s36, 1
  s_add_u32 s68, s68, s55
  s_min_u32 s68, s68, 479
  s_and_b32 s55, s68, 7
  s_mul_i32 s55, s55, 80
  v_lshrrev_b32 v20, 3, v0
  v_mul_u32_u24 v20, 10, v20
  v_add_u32 v20, s55, v20
  s_cmp_lt_u32 s36, 6
  s_cbranch_scc1 L_hc_3
  v_lshlrev_b32 v21, 1, v20
  global_load_dwordx4 v[160:163], v21, s[26:27]
  global_load_dword v164, v21, s[26:27] offset:16
  v_mul_u32_u24 v20, 7680, v20
  v_and_b32 v21, 7, v0
  v_lshl_add_u32 v20, v21, 4, v20
  s_lshr_b32 s55, s68, 3
  s_lshl_b32 s55, s55, 7
  v_add_u32 v20, s55, v20
  s_branch L_nokl_2
L_hc_3:
  s_cmp_lt_u32 s2, 40
  s_cbranch_scc1 L_nokl_2
  global_load_ushort v20, v18, s[6:7] nt
  global_load_ushort v24, v19, s[14:15]
  global_load_ushort v21, v18, s[8:9] nt
  global_load_ushort v22, v18, s[10:11] nt
  global_load_ushort v23, v18, s[12:13] nt
  global_load_ushort v25, v17, s[16:17]
L_nokl_2:
  s_mov_b32 s40, s34
  s_and_b32 s41, s35, 0xffff
  s_mov_b32 s42, 33554432
  s_mov_b32 s43, 0x20000
  s_mov_b32 s44, s20
  s_and_b32 s45, s21, 0xffff
  s_mov_b32 s46, 2211840
  s_mov_b32 s47, 0x20000
  s_mov_b32 s48, s22
  s_and_b32 s49, s23, 0xffff
  s_mov_b32 s50, 2211840
  s_mov_b32 s51, 0x20000
  v_lshrrev_b32 v16, 3, v0
  v_mul_u32_u24 v17, 3456, v16
  v_bfe_u32 v16, v0, 4, 1
  v_bfe_u32 v26, v0, 1, 2
  v_xor_b32 v26, v26, v16
  v_and_b32 v16, 1, v0
  v_lshl_add_u32 v17, v16, 4, v17
  s_lshl_b32 s55, s54, 7
  v_add_u32 v17, s55, v17
  v_lshl_add_u32 v26, v26, 5, v17
  v_xor_b32 v27, 64, v26
  s_mul_i32 s89, s92, 5
  s_mov_b32 s87, 0
  s_lshl_b32 s55, s36, 6
  v_add_u32 v89, s55, v0
  s_lshl_b32 s55, s36, 1
  s_lshr_b32 s56, 0xffa4, s55
  s_and_b32 s56, s56, 3
  s_lshl_b32 s57, s56, 3
  v_lshlrev_b32 v10, 2, v89
  v_add_u32 v11, 0, v10
  v_cvt_f32_u32 v11, v11
  v_cvt_pk_bf16_f32 v11, v11, v11
  v_lshlrev_b32 v11, 16, v11
  v_cvt_u32_f32 v11, v11
  v_lshrrev_b32 v12, 7, v11
  v_and_b32 v13, 7, v11
  v_lshl_add_u32 v12, v12, 3, v13
  v_lshrrev_b32 v12, s56, v12
  v_add_u32 v12, s57, v12
  v_mul_u32_u24 v12, 20, v12
  v_bfe_u32 v11, v11, 3, 4
  v_add_lshl_u32 v11, v12, v11, 2
  v_add_u32 v204, 51200, v11
  v_add_u32 v11, 1, v10
  v_cvt_f32_u32 v11, v11
  v_cvt_pk_bf16_f32 v11, v11, v11
  v_lshlrev_b32 v11, 16, v11
  v_cvt_u32_f32 v11, v11
  v_lshrrev_b32 v12, 7, v11
  v_and_b32 v13, 7, v11
  v_lshl_add_u32 v12, v12, 3, v13
  v_lshrrev_b32 v12, s56, v12
  v_add_u32 v12, s57, v12
  v_mul_u32_u24 v12, 20, v12
  v_bfe_u32 v11, v11, 3, 4
  v_add_lshl_u32 v11, v12, v11, 2
  v_add_u32 v205, 51200, v11
  v_add_u32 v11, 2, v10
  v_cvt_f32_u32 v11, v11
  v_cvt_pk_bf16_f32 v11, v11, v11
  v_lshlrev_b32 v11, 16, v11
  v_cvt_u32_f32 v11, v11
  v_lshrrev_b32 v12, 7, v11
  v_and_b32 v13, 7, v11
  v_lshl_add_u32 v12, v12, 3, v13
  v_lshrrev_b32 v12, s56, v12
  v_add_u32 v12, s57, v12
  v_mul_u32_u24 v12, 20, v12
  v_bfe_u32 v11, v11, 3, 4
  v_add_lshl_u32 v11, v12, v11, 2
  v_add_u32 v206, 51200, v11
  v_add_u32 v11, 3, v10
  v_cvt_f32_u32 v11, v11
  v_cvt_pk_bf16_f32 v11, v11, v11
  v_lshlrev_b32 v11, 16, v11
  v_cvt_u32_f32 v11, v11
  v_lshrrev_b32 v12, 7, v11
  v_and_b32 v13, 7, v11
  v_lshl_add_u32 v12, v12, 3, v13
  v_lshrrev_b32 v12, s56, v12
  v_add_u32 v12, s57, v12
  v_mul_u32_u24 v12, 20, v12
  v_bfe_u32 v11, v11, 3, 4
  v_add_lshl_u32 v11, v12, v11, 2
  v_add_u32 v207, 51200, v11
  v_lshlrev_b32 v208, 1, v10
  v_lshlrev_b32 v209, 2, v10
  v_add_u32 v11, 0, v89
  v_mul_u32_u24 v12, 0x5556, v11
  v_lshrrev_b32 v12, 16, v12
  v_mul_u32_u24 v13, 3, v12
  v_sub_u32 v11, v11, v13
  v_add_u32 v11, s52, v11
  v_mul_u32_u24 v12, 10368, v12
  v_lshl_add_u32 v210, v11, 4, v12
  v_add_u32 v11, 512, v89
  v_mul_u32_u24 v12, 0x5556, v11
  v_lshrrev_b32 v12, 16, v12
  v_mul_u32_u24 v13, 3, v12
  v_sub_u32 v11, v11, v13
  v_add_u32 v11, s52, v11
  v_mul_u32_u24 v12, 10368, v12
  v_lshl_add_u32 v211, v11, 4, v12
  v_lshlrev_b32 v212, 4, v89
  v_bfe_u32 v214, v0, 3, 2
  s_and_b32 s55, s36, 3
  v_xor_b32 v214, s55, v214
  v_lshrrev_b32 v213, 4, v0
  v_lshlrev_b32 v213, 10, v213
  v_lshl_add_u32 v213, v214, 5, v213
  v_bfe_u32 v214, v0, 2, 2
  v_lshl_add_u32 v213, v214, 7, v213
  v_and_b32 v214, 3, v0
  v_lshl_add_u32 v213, v214, 3, v213
  v_add_u32 v213, 81920, v213
  v_add_u32 v214, 40960, v213
  v_lshrrev_b32 v11, 2, v0
  v_min_u32 v11, 11, v11
  v_mul_u32_u24 v12, 0x5556, v11
  v_lshrrev_b32 v12, 16, v12
  v_mul_u32_u24 v13, 3, v12
  v_sub_u32 v11, v11, v13
  v_cmp_eq_u32 vcc, 3, v12
  s_nop 1
  v_addc_co_u32 v12, vcc, 0, v12, vcc
  v_mul_u32_u24 v12, 640, v12
  v_add3_u32 v11, v11, v12, s52
  v_lshrrev_b32 v12, 6, v11
  v_and_b32 v11, 63, v11
  v_lshlrev_b32 v11, 2, v11
  v_lshl_add_u32 v11, v12, 11, v11
  v_and_b32 v12, 3, v0
  v_lshl_add_u32 v11, v12, 8, v11
  v_add_u32 v88, 786432, v11
  v_min_u32 v89, 319, v89
  v_lshlrev_b32 v90, 3, v89
  v_add_u32 v90, 155136, v90
  v_lshrrev_b32 v8, 4, v0
  v_bfe_u32 v9, v0, 2, 2
  v_and_b32 v10, 3, v0
  v_lshlrev_b32 v11, 1, v10
  v_lshl_add_u32 v11, v8, 2, v11
  v_lshrrev_b32 v12, 1, v9
  v_add_u32 v11, v11, v12
  v_mul_u32_u24 v11, 48, v11
  v_and_b32 v12, 1, v9
  v_lshl_add_u32 v11, v12, 3, v11
  v_add_u32 v1, 1024, v11
  v_sub_u32 v11, v10, v9
  v_lshlrev_b32 v12, 3, v8
  v_sub_u32 v11, v11, v12
  v_lshlrev_b32 v11, 3, v11
  v_add_u32 v2, 27872, v11
  v_lshlrev_b32 v11, 3, v9
  v_lshl_add_u32 v11, v8, 1, v11
  v_lshrrev_b32 v12, 1, v10
  v_add_u32 v11, v11, v12
  v_mul_u32_u24 v11, 48, v11
  v_and_b32 v12, 1, v10
  v_lshl_add_u32 v11, v12, 3, v11
  v_add_u32 v5, 1696, v11
  s_mul_i32 s56, s36, 1344
  s_add_u32 s56, s56, 40032
  v_lshl_add_u32 v6, v0, 4, s56
  v_lshl_add_u32 v7, v0, 2, s56
  v_mul_u32_u24 v4, 1344, v9
  v_lshl_add_u32 v4, v8, 5, v4
  v_lshl_add_u32 v4, v10, 3, v4
  s_and_b32 s55, s36, 1
  s_mul_i32 s56, s55, 640
  s_add_u32 s56, s56, 40032
  v_add_u32 v4, s56, v4
  s_mul_i32 s57, s2, 10368
  s_mul_i32 s56, s55, 5120
  s_add_u32 s57, s57, s56
  v_lshl_add_u32 v3, v0, 4, s57
  s_waitcnt lgkmcnt(0)
  s_add_u32 s93, s93, 0x9e3779b9
  s_and_b32 s55, s2, 7
  s_lshl_b32 s55, s55, 12
  v_lshrrev_b32 v11, 1, v0
  v_lshlrev_b32 v11, 7, v11
  v_and_b32 v12, 1, v0
  v_lshl_add_u32 v11, v12, 5, v11
  v_add_u32 v215, s55, v11
  s_waitcnt vmcnt(0)
  v_mov_b32 v10, v91
  s_cmp_lt_u32 s2, 40
  s_cbranch_scc1 L_nsa_4
  s_cmp_ge_u32 s36, 6
  s_cbranch_scc1 L_nsa_4
  s_cmp_eq_u32 s36, 5
  s_cbranch_scc1 L_sa5_5
  s_mov_b32 s88, s36
  s_cmp_ge_u32 s88, 5
  s_cbranch_scc1 L_wsd_6
  s_add_u32 s55, s88, s89
  s_sub_u32 s56, s55, 40
  s_cselect_b32 s55, s55, s56
  s_lshl_b32 s56, s55, 11
  s_add_u32 m0, s56, 81920
  s_mul_i32 s55, s55, 27648
  s_add_u32 s55, s55, s87
  s_add_u32 s88, s88, 1
  buffer_load_dwordx4 v26, s[44:47], s55 offen  lds
  s_add_u32 m0, s56, 82944
  s_nop 0
  buffer_load_dwordx4 v27, s[48:51], s55 offen  lds
L_wsd_6:
  s_branch L_nsa_4
L_sa5_5:
  s_mul_i32 s55, s89, 27648
  s_lshl_b32 s58, s54, 7
  s_add_u32 s55, s55, s58
  s_add_u32 s55, s55, 1105920
  v_mul_u32_u24 v84, 3456, v0
  v_add_u32 v84, s55, v84
  v_min_u32 v84, 2211836, v84
  s_mov_b32 exec_lo, 0xffffffff
  s_mov_b32 exec_hi, 0xff
  global_load_dword v83, v84, s[20:21]
  s_mov_b64 exec, -1
  v_mul_u32_u24 v84, 3456, v0
  v_add_u32 v84, s55, v84
  v_min_u32 v84, 2211836, v84
  s_mov_b32 exec_lo, 0xffffffff
  s_mov_b32 exec_hi, 0xff
  global_load_dword v83, v84, s[22:23]
  s_mov_b64 exec, -1
L_nsa_4:
  s_mov_b32 s55, 0x3f803f80
  v_mov_b32 v10, 0
  v_mov_b32 v11, 0
  v_dot2_f32_bf16 v10, v92, s55, v10
  v_dot2_f32_bf16 v11, v92, v92, v11
  v_dot2_f32_bf16 v10, v93, s55, v10
  v_dot2_f32_bf16 v11, v93, v93, v11
  v_dot2_f32_bf16 v10, v94, s55, v10
  v_dot2_f32_bf16 v11, v94, v94, v11
  v_dot2_f32_bf16 v10, v95, s55, v10
  v_dot2_f32_bf16 v11, v95, v95, v11
  v_dot2_f32_bf16 v10, v91, s55, v10
  v_dot2_f32_bf16 v11, v91, v91, v11
  s_nop 2
  v_permlane32_swap_b32 v10, v11
  v_add_f32 v10, v10, v11
  s_nop 1
  v_add_f32_dpp v10, v10, v10 row_ror:8 row_mask:0xf bank_mask:0xf
  s_nop 1
  v_add_f32_dpp v10, v10, v10 row_ror:4 row_mask:0xf bank_mask:0xf
  s_nop 1
  v_add_f32_dpp v10, v10, v10 row_ror:2 row_mask:0xf bank_mask:0xf
  s_nop 1
  v_add_f32_dpp v10, v10, v10 row_ror:1 row_mask:0xf bank_mask:0xf
  s_nop 1
  v_add_f32_dpp v10, v10, v10 row_bcast:15 row_mask:0xa bank_mask:0xf
  v_mov_b32 v13, 0x3acccccd
  v_readlane_b32 s55, v10, 31
  v_readlane_b32 s56, v10, 63
  s_lshl_b32 s57, s36, 2
  v_mov_b32 v14, s57
  v_mul_f32 v10, s55, v13
  v_mul_f32 v11, s56, v13
  v_fma_f32 v11, -v10, v10, v11
  v_max_f32 v11, 0, v11
  v_cvt_pk_bf16_f32 v10, v10, v11
  v_and_b32 v11, 0xffff0000, v10
  v_lshlrev_b32 v10, 16, v10
  v_add_f32 v11, 0x3727c5ac, v11
  v_cvt_pk_bf16_f32 v11, v11, v11
  v_lshlrev_b32 v11, 16, v11
  v_sqrt_f32 v11, v11
  v_lshlrev_b32 v15, 16, v92
  v_cvt_pk_bf16_f32 v13, v10, v11
  v_and_b32 v11, 0xffff0000, v13
  v_rcp_f32 v11, v11
  ds_write_b32 v14, v13 offset:50784
  v_mul_f32 v10, -v10, v11
  v_lshlrev_b32 v13, 16, v92
  v_and_b32 v14, 0xffff0000, v92
  v_fma_f32 v13, v13, v11, v10
  v_fma_f32 v14, v14, v11, v10
  v_cvt_pk_bf16_f32 v92, v13, v14
  v_lshlrev_b32 v13, 16, v93
  v_and_b32 v14, 0xffff0000, v93
  v_fma_f32 v13, v13, v11, v10
  v_fma_f32 v14, v14, v11, v10
  v_cvt_pk_bf16_f32 v93, v13, v14
  v_lshlrev_b32 v13, 16, v94
  v_and_b32 v14, 0xffff0000, v94
  v_fma_f32 v13, v13, v11, v10
  v_fma_f32 v14, v14, v11, v10
  v_cvt_pk_bf16_f32 v94, v13, v14
  v_lshlrev_b32 v13, 16, v95
  v_and_b32 v14, 0xffff0000, v95
  v_fma_f32 v13, v13, v11, v10
  v_fma_f32 v14, v14, v11, v10
  v_cvt_pk_bf16_f32 v95, v13, v14
  ds_write_b128 v6, v[92:95]
  v_lshlrev_b32 v13, 16, v91
  v_and_b32 v14, 0xffff0000, v91
  v_fma_f32 v13, v13, v11, v10
  v_fma_f32 v14, v14, v11, v10
  v_cvt_pk_bf16_f32 v91, v13, v14
  ds_write_b32 v7, v91 offset:1024
  s_waitcnt lgkmcnt(0)
  s_barrier
  s_cmp_lt_u32 s36, 6
  s_cbranch_scc1 L_nost_7
  ds_read_b64_tr_b16 v[28:29], v4 offset:0
  ds_read_b64_tr_b16 v[30:31], v4 offset:5376
  ds_read_b64_tr_b16 v[32:33], v4 offset:128
  ds_read_b64_tr_b16 v[34:35], v4 offset:5504
  ds_read_b64_tr_b16 v[36:37], v4 offset:256
  ds_read_b64_tr_b16 v[38:39], v4 offset:5632
  ds_read_b64_tr_b16 v[40:41], v4 offset:384
  ds_read_b64_tr_b16 v[42:43], v4 offset:5760
  ds_read_b64_tr_b16 v[44:45], v4 offset:512
  ds_read_b64_tr_b16 v[46:47], v4 offset:5888
  v_lshlrev_b32 v72, 4, v0
  ds_read_b128 v[68:71], v72 offset:50784
  s_mov_b32 s58, 1048576
  s_mov_b32 s59, 1052672
  s_waitcnt lgkmcnt(9)
  buffer_store_dwordx4 v[28:31], v3, s[40:43], s58 offen offset:0 sc1
  s_waitcnt lgkmcnt(7)
  buffer_store_dwordx4 v[32:35], v3, s[40:43], s58 offen offset:1024 sc1
  s_waitcnt lgkmcnt(5)
  buffer_store_dwordx4 v[36:39], v3, s[40:43], s58 offen offset:2048 sc1
  s_waitcnt lgkmcnt(3)
  buffer_store_dwordx4 v[40:43], v3, s[40:43], s58 offen offset:3072 sc1
  s_waitcnt lgkmcnt(1)
  buffer_store_dwordx4 v[44:47], v3, s[40:43], s59 offen offset:0 sc1
  s_cmp_eq_u32 s36, 6
  s_cbranch_scc1 L_w6_8
  s_waitcnt lgkmcnt(0)
  v_mov_b32 v68, 0
  v_mov_b32 v69, 0
  v_mov_b32 v70, 0
  v_mov_b32 v71, 0
  s_cmp_ge_u32 s2, 30
  s_cbranch_scc1 L_w8_10
  s_add_u32 s56, s2, 30
  s_lshl_b32 s56, s56, 8
  s_add_u32 s56, s56, 147456
  s_mov_b64 exec, 0xffff
  buffer_store_dwordx4 v[68:71], v72, s[40:43], s56 offen sc1
L_w8_10:
  s_mul_i32 s56, s2, 352
  s_add_u32 s56, s56, 32768
  s_mov_b64 exec, 0x3fffff
  s_branch L_w7_9
L_w6_8:
  s_lshl_b32 s56, s2, 5
  s_add_u32 s56, s56, 122880
  s_mov_b64 exec, 3
L_w7_9:
  s_waitcnt lgkmcnt(0)
  buffer_store_dwordx4 v[68:71], v72, s[40:43], s56 offen sc1
  s_cmp_lt_u32 s2, 240
  s_cselect_b64 exec, 0xffff, 0
  v_mov_b32 v74, 0
  v_mov_b32 v75, 0
  v_mov_b32 v76, 0
  v_mov_b32 v77, 0
  s_lshl_b32 s56, s68, 8
  s_add_u32 s69, s56, 786432
  buffer_store_dwordx4 v[74:77], v72, s[40:43], s69 offen sc1
  s_mov_b64 exec, -1
  s_nop 0
  v_mov_b32 v74, 0
  v_mov_b32 v75, 0
  v_mov_b32 v76, 0
  v_mov_b32 v77, 0
  s_lshl_b32 s56, s54, 3
  s_add_u32 s56, s56, s92
  s_lshl_b32 s56, s56, 10
  s_and_b32 s57, s36, 1
  s_lshl_b32 s57, s57, 9
  s_add_u32 s56, s56, s57
  s_add_u32 s56, s56, 3932160
  s_cmp_ge_u32 s2, 40
  s_cselect_b32 exec_lo, -1, 0
  s_mov_b32 exec_hi, 0
  buffer_store_dwordx4 v[74:77], v72, s[40:43], s56 offen sc1
  s_mov_b64 exec, -1
  s_cmp_lt_u32 s2, 240
  s_cselect_b64 exec, -1, 0
  global_load_dwordx4 v[216:219], v20, s[28:29] nt
  v_add_u32 v20, 7680, v20
  global_load_dwordx4 v[220:223], v20, s[28:29] nt
  v_add_u32 v20, 7680, v20
  global_load_dwordx4 v[224:227], v20, s[28:29] nt
  v_add_u32 v20, 7680, v20
  global_load_dwordx4 v[228:231], v20, s[28:29] nt
  v_add_u32 v20, 7680, v20
  global_load_dwordx4 v[232:235], v20, s[28:29] nt
  v_add_u32 v20, 7680, v20
  global_load_dwordx4 v[236:239], v20, s[28:29] nt
  v_add_u32 v20, 7680, v20
  global_load_dwordx4 v[240:243], v20, s[28:29] nt
  v_add_u32 v20, 7680, v20
  global_load_dwordx4 v[244:247], v20, s[28:29] nt
  v_add_u32 v20, 7680, v20
  global_load_dwordx4 v[248:251], v20, s[28:29] nt
  v_add_u32 v20, 7680, v20
  global_load_dwordx4 v[252:255], v20, s[28:29] nt
  s_mov_b64 exec, -1
  v_lshlrev_b32 v140, 16, v160
  v_mul_f32 v150, 0xbfb8aa3b, v140
  v_and_b32 v141, 0xffff0000, v160
  v_mul_f32 v151, 0xbfb8aa3b, v141
  v_lshlrev_b32 v142, 16, v161
  v_mul_f32 v152, 0xbfb8aa3b, v142
  v_and_b32 v143, 0xffff0000, v161
  v_mul_f32 v153, 0xbfb8aa3b, v143
  v_lshlrev_b32 v144, 16, v162
  v_mul_f32 v154, 0xbfb8aa3b, v144
  v_and_b32 v145, 0xffff0000, v162
  v_mul_f32 v155, 0xbfb8aa3b, v145
  v_lshlrev_b32 v146, 16, v163
  v_mul_f32 v156, 0xbfb8aa3b, v146
  v_and_b32 v147, 0xffff0000, v163
  v_mul_f32 v157, 0xbfb8aa3b, v147
  v_lshlrev_b32 v148, 16, v164
  v_mul_f32 v158, 0xbfb8aa3b, v148
  v_and_b32 v149, 0xffff0000, v164
  v_mul_f32 v159, 0xbfb8aa3b, v149
  v_exp_f32 v150, v150
  v_exp_f32 v151, v151
  v_exp_f32 v152, v152
  v_exp_f32 v153, v153
  v_exp_f32 v154, v154
  v_exp_f32 v155, v155
  v_exp_f32 v156, v156
  v_exp_f32 v157, v157
  v_exp_f32 v158, v158
  v_exp_f32 v159, v159
  v_add_f32 v150, 1.0, v150
  v_add_f32 v151, 1.0, v151
  v_add_f32 v152, 1.0, v152
  v_add_f32 v153, 1.0, v153
  v_add_f32 v154, 1.0, v154
  v_add_f32 v155, 1.0, v155
  v_add_f32 v156, 1.0, v156
  v_add_f32 v157, 1.0, v157
  v_add_f32 v158, 1.0, v158
  v_add_f32 v159, 1.0, v159
  v_rcp_f32 v150, v150
  v_rcp_f32 v151, v151
  v_rcp_f32 v152, v152
  v_rcp_f32 v153, v153
  v_rcp_f32 v154, v154
  v_rcp_f32 v155, v155
  v_rcp_f32 v156, v156
  v_rcp_f32 v157, v157
  v_rcp_f32 v158, v158
  v_rcp_f32 v159, v159
  v_mul_f32 v140, v140, v150
  v_mul_f32 v141, v141, v151
  v_mul_f32 v142, v142, v152
  v_mul_f32 v143, v143, v153
  v_mul_f32 v144, v144, v154
  v_mul_f32 v145, v145, v155
  v_mul_f32 v146, v146, v156
  v_mul_f32 v147, v147, v157
  v_mul_f32 v148, v148, v158
  v_mul_f32 v149, v149, v159
  v_cvt_pk_bf16_f32 v140, v140, v140
  v_cvt_pk_bf16_f32 v141, v141, v141
  v_cvt_pk_bf16_f32 v142, v142, v142
  v_cvt_pk_bf16_f32 v143, v143, v143
  v_cvt_pk_bf16_f32 v144, v144, v144
  v_cvt_pk_bf16_f32 v145, v145, v145
  v_cvt_pk_bf16_f32 v146, v146, v146
  v_cvt_pk_bf16_f32 v147, v147, v147
  v_cvt_pk_bf16_f32 v148, v148, v148
  v_cvt_pk_bf16_f32 v149, v149, v149
  v_lshlrev_b32 v140, 16, v140
  v_lshlrev_b32 v141, 16, v141
  v_lshlrev_b32 v142, 16, v142
  v_lshlrev_b32 v143, 16, v143
  v_lshlrev_b32 v144, 16, v144
  v_lshlrev_b32 v145, 16, v145
  v_lshlrev_b32 v146, 16, v146
  v_lshlrev_b32 v147, 16, v147
  v_lshlrev_b32 v148, 16, v148
  v_lshlrev_b32 v149, 16, v149
  s_mov_b64 exec, -1
  s_lshr_b32 s56, s2, 3
  s_lshl_b32 s56, s56, 7
  s_and_b32 s57, s2, 7
  s_lshl_b32 s57, s57, 3
  s_add_u32 s56, s56, s57
  s_and_b32 s57, s36, 1
  s_lshl_b32 s57, s57, 2
  s_add_u32 s56, s56, s57
  v_lshl_add_u32 v16, v0, 12, s56
  v_mov_b32 v17, s93
  s_mov_b64 exec, 0xff
  s_waitcnt vmcnt(10)
  global_store_dword v16, v17, s[34:35] offset:0 sc1
  s_mov_b64 exec, -1
L_nost_7:
  s_cmp_lt_u32 s2, 40
  s_cbranch_scc1 L_helper
  s_cmp_ge_u32 s36, 6
  s_cbranch_scc1 L_nokg_12
  v_lshlrev_b32 v24, 16, v24
  v_lshlrev_b32 v20, 16, v20
  v_mul_f32 v24, 0x3fb8aa3b, v24
  v_mul_f32 v20, 0x3fb8aa3b, v20
  v_exp_f32 v24, v24
  v_exp_f32 v20, v20
  v_lshlrev_b32 v21, 16, v21
  v_cvt_pk_bf16_f32 v20, v20, v24
  v_and_b32 v24, 0xffff0000, v20
  v_lshlrev_b32 v20, 16, v20
  v_mul_f32 v28, v20, v24
  v_mul_f32 v29, v21, v24
  v_mul_f32 v28, 0xbfb8aa3b, v28
  v_mul_f32 v29, 0.15915494, v29
  v_add_f32 v24, v24, v24
  v_lshlrev_b32 v22, 16, v22
  v_lshlrev_b32 v23, 16, v23
  v_mul_f32 v52, v22, v24
  v_mul_f32 v53, v23, v24
  s_mul_i32 s60, s36, 4608
  s_mov_b32 m0, s60
  v_and_b32 v80, 15, v0
  v_mul_u32_u24 v80, 288, v80
  v_lshrrev_b32 v81, 4, v0
  v_lshl_add_u32 v80, v81, 4, v80
  v_add_u32 v80, s60, v80
  v_mul_f32 v30, 0x41000000, v28
  v_mul_f32 v31, 0x41000000, v29
  v_exp_f32 v30, v30
  v_fract_f32 v31, v31
  v_cos_f32 v48, v31
  v_sin_f32 v49, v31
  v_mul_f32 v48, v48, v30
  v_mul_f32 v49, v49, v30
  v_mul_f32 v30, 0x3f800000, v28
  v_mul_f32 v31, 0x3f800000, v29
  v_exp_f32 v30, v30
  v_fract_f32 v31, v31
  v_cos_f32 v34, v31
  v_sin_f32 v35, v31
  v_mul_f32 v34, v34, v30
  v_mul_f32 v35, v35, v30
  v_mul_f32 v30, 0x43000000, v28
  v_mul_f32 v31, 0x43000000, v29
  v_exp_f32 v30, v30
  v_fract_f32 v31, v31
  v_cos_f32 v50, v31
  v_sin_f32 v51, v31
  v_mul_f32 v50, v50, v30
  v_mul_f32 v51, v51, v30
  v_pk_mul_f32 v[54:55], v[52:53], v[48:49] op_sel:[0,0] op_sel_hi:[0,1]
  v_pk_fma_f32 v[54:55], v[52:53], v[48:49], v[54:55] op_sel:[1,1,0] op_sel_hi:[1,0,1] neg_lo:[1,0,0]
  v_cvt_pk_bf16_f32 v62, v52, -v53
  ds_write_addtid_b32 v62 offset:0
  v_pk_mul_f32 v[36:37], v[34:35], v[34:35] op_sel:[0,0] op_sel_hi:[0,1]
  v_pk_fma_f32 v[36:37], v[34:35], v[34:35], v[36:37] op_sel:[1,1,0] op_sel_hi:[1,0,1] neg_lo:[1,0,0]
  v_pk_mul_f32 v[52:53], v[54:55], v[48:49] op_sel:[0,0] op_sel_hi:[0,1]
  v_pk_fma_f32 v[52:53], v[54:55], v[48:49], v[52:53] op_sel:[1,1,0] op_sel_hi:[1,0,1] neg_lo:[1,0,0]
  v_cvt_pk_bf16_f32 v63, v54, -v55
  ds_write_addtid_b32 v63 offset:288
  v_pk_mul_f32 v[38:39], v[36:37], v[34:35] op_sel:[0,0] op_sel_hi:[0,1]
  v_pk_fma_f32 v[38:39], v[36:37], v[34:35], v[38:39] op_sel:[1,1,0] op_sel_hi:[1,0,1] neg_lo:[1,0,0]
  v_pk_mul_f32 v[54:55], v[52:53], v[48:49] op_sel:[0,0] op_sel_hi:[0,1]
  v_pk_fma_f32 v[54:55], v[52:53], v[48:49], v[54:55] op_sel:[1,1,0] op_sel_hi:[1,0,1] neg_lo:[1,0,0]
  v_cvt_pk_bf16_f32 v62, v52, -v53
  ds_write_addtid_b32 v62 offset:576
  v_pk_mul_f32 v[40:41], v[36:37], v[36:37] op_sel:[0,0] op_sel_hi:[0,1]
  v_pk_fma_f32 v[40:41], v[36:37], v[36:37], v[40:41] op_sel:[1,1,0] op_sel_hi:[1,0,1] neg_lo:[1,0,0]
  v_pk_mul_f32 v[52:53], v[54:55], v[48:49] op_sel:[0,0] op_sel_hi:[0,1]
  v_pk_fma_f32 v[52:53], v[54:55], v[48:49], v[52:53] op_sel:[1,1,0] op_sel_hi:[1,0,1] neg_lo:[1,0,0]
  v_cvt_pk_bf16_f32 v63, v54, -v55
  ds_write_addtid_b32 v63 offset:864
  v_pk_mul_f32 v[42:43], v[40:41], v[34:35] op_sel:[0,0] op_sel_hi:[0,1]
  v_pk_fma_f32 v[42:43], v[40:41], v[34:35], v[42:43] op_sel:[1,1,0] op_sel_hi:[1,0,1] neg_lo:[1,0,0]
  v_pk_mul_f32 v[54:55], v[52:53], v[48:49] op_sel:[0,0] op_sel_hi:[0,1]
  v_pk_fma_f32 v[54:55], v[52:53], v[48:49], v[54:55] op_sel:[1,1,0] op_sel_hi:[1,0,1] neg_lo:[1,0,0]
  v_cvt_pk_bf16_f32 v62, v52, -v53
  ds_write_addtid_b32 v62 offset:1152
  v_pk_mul_f32 v[44:45], v[40:41], v[36:37] op_sel:[0,0] op_sel_hi:[0,1]
  v_pk_fma_f32 v[44:45], v[40:41], v[36:37], v[44:45] op_sel:[1,1,0] op_sel_hi:[1,0,1] neg_lo:[1,0,0]
  v_pk_mul_f32 v[52:53], v[54:55], v[48:49] op_sel:[0,0] op_sel_hi:[0,1]
  v_pk_fma_f32 v[52:53], v[54:55], v[48:49], v[52:53] op_sel:[1,1,0] op_sel_hi:[1,0,1] neg_lo:[1,0,0]
  v_cvt_pk_bf16_f32 v63, v54, -v55
  ds_write_addtid_b32 v63 offset:1440
  v_pk_mul_f32 v[46:47], v[40:41], v[38:39] op_sel:[0,0] op_sel_hi:[0,1]
  v_pk_fma_f32 v[46:47], v[40:41], v[38:39], v[46:47] op_sel:[1,1,0] op_sel_hi:[1,0,1] neg_lo:[1,0,0]
  v_pk_mul_f32 v[54:55], v[52:53], v[48:49] op_sel:[0,0] op_sel_hi:[0,1]
  v_pk_fma_f32 v[54:55], v[52:53], v[48:49], v[54:55] op_sel:[1,1,0] op_sel_hi:[1,0,1] neg_lo:[1,0,0]
  v_cvt_pk_bf16_f32 v62, v52, -v53
  ds_write_addtid_b32 v62 offset:1728
  v_pk_mul_f32 v[52:53], v[54:55], v[48:49] op_sel:[0,0] op_sel_hi:[0,1]
  v_pk_fma_f32 v[52:53], v[54:55], v[48:49], v[52:53] op_sel:[1,1,0] op_sel_hi:[1,0,1] neg_lo:[1,0,0]
  v_cvt_pk_bf16_f32 v63, v54, -v55
  ds_write_addtid_b32 v63 offset:2016
  v_pk_mul_f32 v[54:55], v[52:53], v[48:49] op_sel:[0,0] op_sel_hi:[0,1]
  v_pk_fma_f32 v[54:55], v[52:53], v[48:49], v[54:55] op_sel:[1,1,0] op_sel_hi:[1,0,1] neg_lo:[1,0,0]
  v_cvt_pk_bf16_f32 v62, v52, -v53
  ds_write_addtid_b32 v62 offset:2304
  v_pk_mul_f32 v[52:53], v[54:55], v[48:49] op_sel:[0,0] op_sel_hi:[0,1]
  v_pk_fma_f32 v[52:53], v[54:55], v[48:49], v[52:53] op_sel:[1,1,0] op_sel_hi:[1,0,1] neg_lo:[1,0,0]
  v_cvt_pk_bf16_f32 v63, v54, -v55
  ds_write_addtid_b32 v63 offset:2592
  v_pk_mul_f32 v[54:55], v[52:53], v[48:49] op_sel:[0,0] op_sel_hi:[0,1]
  v_pk_fma_f32 v[54:55], v[52:53], v[48:49], v[54:55] op_sel:[1,1,0] op_sel_hi:[1,0,1] neg_lo:[1,0,0]
  v_cvt_pk_bf16_f32 v62, v52, -v53
  ds_write_addtid_b32 v62 offset:2880
  v_pk_mul_f32 v[52:53], v[54:55], v[48:49] op_sel:[0,0] op_sel_hi:[0,1]
  v_pk_fma_f32 v[52:53], v[54:55], v[48:49], v[52:53] op_sel:[1,1,0] op_sel_hi:[1,0,1] neg_lo:[1,0,0]
  v_cvt_pk_bf16_f32 v63, v54, -v55
  ds_write_addtid_b32 v63 offset:3168
  v_pk_mul_f32 v[54:55], v[52:53], v[48:49] op_sel:[0,0] op_sel_hi:[0,1]
  v_pk_fma_f32 v[54:55], v[52:53], v[48:49], v[54:55] op_sel:[1,1,0] op_sel_hi:[1,0,1] neg_lo:[1,0,0]
  v_cvt_pk_bf16_f32 v62, v52, -v53
  ds_write_addtid_b32 v62 offset:3456
  v_pk_mul_f32 v[52:53], v[54:55], v[48:49] op_sel:[0,0] op_sel_hi:[0,1]
  v_pk_fma_f32 v[52:53], v[54:55], v[48:49], v[52:53] op_sel:[1,1,0] op_sel_hi:[1,0,1] neg_lo:[1,0,0]
  v_cvt_pk_bf16_f32 v63, v54, -v55
  ds_write_addtid_b32 v63 offset:3744
  v_pk_mul_f32 v[54:55], v[52:53], v[48:49] op_sel:[0,0] op_sel_hi:[0,1]
  v_pk_fma_f32 v[54:55], v[52:53], v[48:49], v[54:55] op_sel:[1,1,0] op_sel_hi:[1,0,1] neg_lo:[1,0,0]
  v_cvt_pk_bf16_f32 v62, v52, -v53
  ds_write_addtid_b32 v62 offset:4032
  v_cvt_pk_bf16_f32 v63, v54, -v55
  ds_write_addtid_b32 v63 offset:4320
  ds_read_b128 v[64:67], v80 offset:0
  ds_read_b128 v[68:71], v80 offset:64
  ds_read_b128 v[72:75], v80 offset:128
  ds_read_b128 v[76:79], v80 offset:192
  v_mov_b32 v62, 0x3f80
  ds_write_addtid_b32 v62 offset:0
  v_cvt_pk_bf16_f32 v63, v50, v51
  ds_write_addtid_b32 v63 offset:2304
  v_pk_mul_f32 v[56:57], v[34:35], v[50:51] op_sel:[0,0] op_sel_hi:[0,1]
  v_pk_fma_f32 v[56:57], v[34:35], v[50:51], v[56:57] op_sel:[1,1,0] op_sel_hi:[1,0,1] neg_lo:[1,0,0]
  v_cvt_pk_bf16_f32 v62, v34, v35
  ds_write_addtid_b32 v62 offset:288
  v_cvt_pk_bf16_f32 v63, v56, v57
  ds_write_addtid_b32 v63 offset:2592
  v_pk_mul_f32 v[58:59], v[36:37], v[50:51] op_sel:[0,0] op_sel_hi:[0,1]
  v_pk_fma_f32 v[58:59], v[36:37], v[50:51], v[58:59] op_sel:[1,1,0] op_sel_hi:[1,0,1] neg_lo:[1,0,0]
  v_cvt_pk_bf16_f32 v62, v36, v37
  ds_write_addtid_b32 v62 offset:576
  v_cvt_pk_bf16_f32 v63, v58, v59
  ds_write_addtid_b32 v63 offset:2880
  v_pk_mul_f32 v[56:57], v[38:39], v[50:51] op_sel:[0,0] op_sel_hi:[0,1]
  v_pk_fma_f32 v[56:57], v[38:39], v[50:51], v[56:57] op_sel:[1,1,0] op_sel_hi:[1,0,1] neg_lo:[1,0,0]
  v_cvt_pk_bf16_f32 v62, v38, v39
  ds_write_addtid_b32 v62 offset:864
  v_cvt_pk_bf16_f32 v63, v56, v57
  ds_write_addtid_b32 v63 offset:3168
  v_pk_mul_f32 v[58:59], v[40:41], v[50:51] op_sel:[0,0] op_sel_hi:[0,1]
  v_pk_fma_f32 v[58:59], v[40:41], v[50:51], v[58:59] op_sel:[1,1,0] op_sel_hi:[1,0,1] neg_lo:[1,0,0]
  v_cvt_pk_bf16_f32 v62, v40, v41
  ds_write_addtid_b32 v62 offset:1152
  v_cvt_pk_bf16_f32 v63, v58, v59
  ds_write_addtid_b32 v63 offset:3456
  v_pk_mul_f32 v[56:57], v[42:43], v[50:51] op_sel:[0,0] op_sel_hi:[0,1]
  v_pk_fma_f32 v[56:57], v[42:43], v[50:51], v[56:57] op_sel:[1,1,0] op_sel_hi:[1,0,1] neg_lo:[1,0,0]
  v_cvt_pk_bf16_f32 v62, v42, v43
  ds_write_addtid_b32 v62 offset:1440
  v_cvt_pk_bf16_f32 v63, v56, v57
  ds_write_addtid_b32 v63 offset:3744
  v_pk_mul_f32 v[58:59], v[44:45], v[50:51] op_sel:[0,0] op_sel_hi:[0,1]
  v_pk_fma_f32 v[58:59], v[44:45], v[50:51], v[58:59] op_sel:[1,1,0] op_sel_hi:[1,0,1] neg_lo:[1,0,0]
  v_cvt_pk_bf16_f32 v62, v44, v45
  ds_write_addtid_b32 v62 offset:1728
  v_cvt_pk_bf16_f32 v63, v58, v59
  ds_write_addtid_b32 v63 offset:4032
  v_pk_mul_f32 v[56:57], v[46:47], v[50:51] op_sel:[0,0] op_sel_hi:[0,1]
  v_pk_fma_f32 v[56:57], v[46:47], v[50:51], v[56:57] op_sel:[1,1,0] op_sel_hi:[1,0,1] neg_lo:[1,0,0]
  v_cvt_pk_bf16_f32 v62, v46, v47
  ds_write_addtid_b32 v62 offset:2016
  v_cvt_pk_bf16_f32 v63, v56, v57
  ds_write_addtid_b32 v63 offset:4320
  ds_read_b128 v[176:179], v80 offset:0
  ds_read_b128 v[180:183], v80 offset:64
  ds_read_b128 v[184:187], v80 offset:128
  ds_read_b128 v[188:191], v80 offset:192
  v_pk_mul_f32 v[52:53], v[50:51], v[50:51] op_sel:[0,0] op_sel_hi:[0,1]
  v_pk_fma_f32 v[52:53], v[50:51], v[50:51], v[52:53] op_sel:[1,1,0] op_sel_hi:[1,0,1] neg_lo:[1,0,0]
  v_pk_mul_f32 v[54:55], v[52:53], v[50:51] op_sel:[0,0] op_sel_hi:[0,1]
  v_pk_fma_f32 v[54:55], v[52:53], v[50:51], v[54:55] op_sel:[1,1,0] op_sel_hi:[1,0,1] neg_lo:[1,0,0]
  s_waitcnt lgkmcnt(3)
  v_mfma_f32_16x16x32_bf16 v[192:195], v[176:179], v[64:67], 0
  s_waitcnt lgkmcnt(2)
  v_mfma_f32_16x16x32_bf16 v[192:195], v[180:183], v[68:71], v[192:195]
  s_waitcnt lgkmcnt(1)
  v_mfma_f32_16x16x32_bf16 v[192:195], v[184:187], v[72:75], v[192:195]
  s_waitcnt lgkmcnt(0)
  v_mfma_f32_16x16x32_bf16 v[192:195], v[188:191], v[76:79], v[192:195]
  v_cvt_pk_bf16_f32 v62, v52, v53
  ds_write_addtid_b32 v62 offset:0
  v_cvt_pk_bf16_f32 v63, v54, v55
  ds_write_addtid_b32 v63 offset:1152
  v_pk_mul_f32 v[56:57], v[52:53], v[36:37] op_sel:[0,0] op_sel_hi:[0,1]
  v_pk_fma_f32 v[56:57], v[52:53], v[36:37], v[56:57] op_sel:[1,1,0] op_sel_hi:[1,0,1] neg_lo:[1,0,0]
  v_pk_mul_f32 v[58:59], v[54:55], v[36:37] op_sel:[0,0] op_sel_hi:[0,1]
  v_pk_fma_f32 v[58:59], v[54:55], v[36:37], v[58:59] op_sel:[1,1,0] op_sel_hi:[1,0,1] neg_lo:[1,0,0]
  v_cvt_pk_bf16_f32 v62, v56, v57
  ds_write_addtid_b32 v62 offset:288
  v_cvt_pk_bf16_f32 v63, v58, v59
  ds_write_addtid_b32 v63 offset:1440
  v_pk_mul_f32 v[56:57], v[52:53], v[40:41] op_sel:[0,0] op_sel_hi:[0,1]
  v_pk_fma_f32 v[56:57], v[52:53], v[40:41], v[56:57] op_sel:[1,1,0] op_sel_hi:[1,0,1] neg_lo:[1,0,0]
  v_pk_mul_f32 v[58:59], v[54:55], v[40:41] op_sel:[0,0] op_sel_hi:[0,1]
  v_pk_fma_f32 v[58:59], v[54:55], v[40:41], v[58:59] op_sel:[1,1,0] op_sel_hi:[1,0,1] neg_lo:[1,0,0]
  v_cvt_pk_bf16_f32 v62, v56, v57
  ds_write_addtid_b32 v62 offset:576
  v_cvt_pk_bf16_f32 v63, v58, v59
  ds_write_addtid_b32 v63 offset:1728
  v_pk_mul_f32 v[56:57], v[52:53], v[44:45] op_sel:[0,0] op_sel_hi:[0,1]
  v_pk_fma_f32 v[56:57], v[52:53], v[44:45], v[56:57] op_sel:[1,1,0] op_sel_hi:[1,0,1] neg_lo:[1,0,0]
  v_pk_mul_f32 v[58:59], v[54:55], v[44:45] op_sel:[0,0] op_sel_hi:[0,1]
  v_pk_fma_f32 v[58:59], v[54:55], v[44:45], v[58:59] op_sel:[1,1,0] op_sel_hi:[1,0,1] neg_lo:[1,0,0]
  v_cvt_pk_bf16_f32 v62, v56, v57
  ds_write_addtid_b32 v62 offset:864
  v_cvt_pk_bf16_f32 v63, v58, v59
  ds_write_addtid_b32 v63 offset:2016
  v_pk_mul_f32 v[52:53], v[54:55], v[50:51] op_sel:[0,0] op_sel_hi:[0,1]
  v_pk_fma_f32 v[52:53], v[54:55], v[50:51], v[52:53] op_sel:[1,1,0] op_sel_hi:[1,0,1] neg_lo:[1,0,0]
  v_pk_mul_f32 v[56:57], v[52:53], v[40:41] op_sel:[0,0] op_sel_hi:[0,1]
  v_pk_fma_f32 v[56:57], v[52:53], v[40:41], v[56:57] op_sel:[1,1,0] op_sel_hi:[1,0,1] neg_lo:[1,0,0]
  v_cvt_pk_bf16_f32 v62, v52, v53
  ds_write_addtid_b32 v62 offset:2304
  v_cvt_pk_bf16_f32 v63, v56, v57
  ds_write_addtid_b32 v63 offset:2592
  v_pk_mul_f32 v[54:55], v[52:53], v[50:51] op_sel:[0,0] op_sel_hi:[0,1]
  v_pk_fma_f32 v[54:55], v[52:53], v[50:51], v[54:55] op_sel:[1,1,0] op_sel_hi:[1,0,1] neg_lo:[1,0,0]
  v_pk_mul_f32 v[56:57], v[54:55], v[40:41] op_sel:[0,0] op_sel_hi:[0,1]
  v_pk_fma_f32 v[56:57], v[54:55], v[40:41], v[56:57] op_sel:[1,1,0] op_sel_hi:[1,0,1] neg_lo:[1,0,0]
  v_cvt_pk_bf16_f32 v62, v54, v55
  ds_write_addtid_b32 v62 offset:2880
  v_cvt_pk_bf16_f32 v63, v56, v57
  ds_write_addtid_b32 v63 offset:3168
  v_pk_mul_f32 v[52:53], v[54:55], v[50:51] op_sel:[0,0] op_sel_hi:[0,1]
  v_pk_fma_f32 v[52:53], v[54:55], v[50:51], v[52:53] op_sel:[1,1,0] op_sel_hi:[1,0,1] neg_lo:[1,0,0]
  v_pk_mul_f32 v[56:57], v[52:53], v[40:41] op_sel:[0,0] op_sel_hi:[0,1]
  v_pk_fma_f32 v[56:57], v[52:53], v[40:41], v[56:57] op_sel:[1,1,0] op_sel_hi:[1,0,1] neg_lo:[1,0,0]
  v_cvt_pk_bf16_f32 v62, v52, v53
  ds_write_addtid_b32 v62 offset:3456
  v_cvt_pk_bf16_f32 v63, v56, v57
  ds_write_addtid_b32 v63 offset:3744
  v_pk_mul_f32 v[54:55], v[52:53], v[50:51] op_sel:[0,0] op_sel_hi:[0,1]
  v_pk_fma_f32 v[54:55], v[52:53], v[50:51], v[54:55] op_sel:[1,1,0] op_sel_hi:[1,0,1] neg_lo:[1,0,0]
  v_pk_mul_f32 v[56:57], v[54:55], v[40:41] op_sel:[0,0] op_sel_hi:[0,1]
  v_pk_fma_f32 v[56:57], v[54:55], v[40:41], v[56:57] op_sel:[1,1,0] op_sel_hi:[1,0,1] neg_lo:[1,0,0]
  v_cvt_pk_bf16_f32 v62, v54, v55
  ds_write_addtid_b32 v62 offset:4032
  v_cvt_pk_bf16_f32 v63, v56, v57
  ds_write_addtid_b32 v63 offset:4320
  ds_read_b128 v[176:179], v80 offset:0
  ds_read_b128 v[180:183], v80 offset:64
  ds_read_b128 v[184:187], v80 offset:128
  ds_read_b128 v[188:191], v80 offset:192
  v_pk_mul_f32 v[52:53], v[54:55], v[50:51] op_sel:[0,0] op_sel_hi:[0,1]
  v_pk_fma_f32 v[52:53], v[54:55], v[50:51], v[52:53] op_sel:[1,1,0] op_sel_hi:[1,0,1] neg_lo:[1,0,0]
  s_waitcnt lgkmcnt(3)
  v_mfma_f32_16x16x32_bf16 v[196:199], v[176:179], v[64:67], 0
  s_waitcnt lgkmcnt(2)
  v_mfma_f32_16x16x32_bf16 v[196:199], v[180:183], v[68:71], v[196:199]
  s_waitcnt lgkmcnt(1)
  v_mfma_f32_16x16x32_bf16 v[196:199], v[184:187], v[72:75], v[196:199]
  s_waitcnt lgkmcnt(0)
  v_mfma_f32_16x16x32_bf16 v[196:199], v[188:191], v[76:79], v[196:199]
  v_pk_mul_f32 v[54:55], v[52:53], v[50:51] op_sel:[0,0] op_sel_hi:[0,1]
  v_pk_fma_f32 v[54:55], v[52:53], v[50:51], v[54:55] op_sel:[1,1,0] op_sel_hi:[1,0,1] neg_lo:[1,0,0]
  v_cvt_pk_bf16_f32 v62, v52, v53
  ds_write_addtid_b32 v62 offset:0
  v_pk_mul_f32 v[52:53], v[54:55], v[50:51] op_sel:[0,0] op_sel_hi:[0,1]
  v_pk_fma_f32 v[52:53], v[54:55], v[50:51], v[52:53] op_sel:[1,1,0] op_sel_hi:[1,0,1] neg_lo:[1,0,0]
  v_cvt_pk_bf16_f32 v63, v54, v55
  ds_write_addtid_b32 v63 offset:288
  v_pk_mul_f32 v[54:55], v[52:53], v[50:51] op_sel:[0,0] op_sel_hi:[0,1]
  v_pk_fma_f32 v[54:55], v[52:53], v[50:51], v[54:55] op_sel:[1,1,0] op_sel_hi:[1,0,1] neg_lo:[1,0,0]
  v_cvt_pk_bf16_f32 v62, v52, v53
  ds_write_addtid_b32 v62 offset:576
  v_pk_mul_f32 v[52:53], v[54:55], v[50:51] op_sel:[0,0] op_sel_hi:[0,1]
  v_pk_fma_f32 v[52:53], v[54:55], v[50:51], v[52:53] op_sel:[1,1,0] op_sel_hi:[1,0,1] neg_lo:[1,0,0]
  v_cvt_pk_bf16_f32 v63, v54, v55
  ds_write_addtid_b32 v63 offset:864
  v_pk_mul_f32 v[54:55], v[52:53], v[50:51] op_sel:[0,0] op_sel_hi:[0,1]
  v_pk_fma_f32 v[54:55], v[52:53], v[50:51], v[54:55] op_sel:[1,1,0] op_sel_hi:[1,0,1] neg_lo:[1,0,0]
  v_cvt_pk_bf16_f32 v62, v52, v53
  ds_write_addtid_b32 v62 offset:1152
  v_pk_mul_f32 v[52:53], v[54:55], v[50:51] op_sel:[0,0] op_sel_hi:[0,1]
  v_pk_fma_f32 v[52:53], v[54:55], v[50:51], v[52:53] op_sel:[1,1,0] op_sel_hi:[1,0,1] neg_lo:[1,0,0]
  v_cvt_pk_bf16_f32 v63, v54, v55
  ds_write_addtid_b32 v63 offset:1440
  v_pk_mul_f32 v[54:55], v[52:53], v[50:51] op_sel:[0,0] op_sel_hi:[0,1]
  v_pk_fma_f32 v[54:55], v[52:53], v[50:51], v[54:55] op_sel:[1,1,0] op_sel_hi:[1,0,1] neg_lo:[1,0,0]
  v_cvt_pk_bf16_f32 v62, v52, v53
  ds_write_addtid_b32 v62 offset:1728
  v_pk_mul_f32 v[52:53], v[54:55], v[50:51] op_sel:[0,0] op_sel_hi:[0,1]
  v_pk_fma_f32 v[52:53], v[54:55], v[50:51], v[52:53] op_sel:[1,1,0] op_sel_hi:[1,0,1] neg_lo:[1,0,0]
  v_cvt_pk_bf16_f32 v63, v54, v55
  ds_write_addtid_b32 v63 offset:2016
  v_cvt_pk_bf16_f32 v62, v52, v53
  ds_write_addtid_b32 v62 offset:2304
  ds_read_b128 v[176:179], v80 offset:0
  ds_read_b128 v[180:183], v80 offset:64
  ds_read_b128 v[184:187], v80 offset:128
  ds_read_b128 v[188:191], v80 offset:192
  v_lshrrev_b32 v81, 4, v0
  v_mul_u32_u24 v81, 320, v81
  v_and_b32 v82, 15, v0
  v_lshl_add_u32 v81, v82, 2, v81
  s_mul_i32 s55, s36, 3840
  s_add_u32 s55, s55, 51200
  v_add_u32 v81, s55, v81
  ds_write_b32 v81, v192 offset:0
  ds_write_b32 v81, v193 offset:80
  ds_write_b32 v81, v194 offset:160
  ds_write_b32 v81, v195 offset:240
  ds_write_b32 v81, v196 offset:1280
  ds_write_b32 v81, v197 offset:1360
  ds_write_b32 v81, v198 offset:1440
  ds_write_b32 v81, v199 offset:1520
  s_waitcnt lgkmcnt(11)
  v_mfma_f32_16x16x32_bf16 v[200:203], v[176:179], v[64:67], 0
  s_waitcnt lgkmcnt(10)
  v_mfma_f32_16x16x32_bf16 v[200:203], v[180:183], v[68:71], v[200:203]
  s_waitcnt lgkmcnt(9)
  v_mfma_f32_16x16x32_bf16 v[200:203], v[184:187], v[72:75], v[200:203]
  s_waitcnt lgkmcnt(8)
  v_mfma_f32_16x16x32_bf16 v[200:203], v[188:191], v[76:79], v[200:203]
  s_nop 7
  ds_write_b32 v81, v200 offset:2560
  ds_write_b32 v81, v201 offset:2640
  ds_write_b32 v81, v202 offset:2720
  ds_write_b32 v81, v203 offset:2800
  s_cmp_ge_u32 s36, 4
  s_cbranch_scc1 L_nokg_12
  s_add_u32 s88, s36, 5
  s_cmp_ge_u32 s88, 25
  s_cbranch_scc1 L_wsd_13
  s_add_u32 s55, s88, s89
  s_sub_u32 s56, s55, 40
  s_cselect_b32 s55, s55, s56
  s_lshl_b32 s56, s55, 11
  s_add_u32 m0, s56, 81920
  s_mul_i32 s55, s55, 27648
  s_add_u32 s55, s55, s87
  s_add_u32 s88, s88, 4
  buffer_load_dwordx4 v26, s[44:47], s55 offen  lds
  s_add_u32 m0, s56, 82944
  s_nop 0
  buffer_load_dwordx4 v27, s[48:51], s55 offen  lds
  s_cmp_ge_u32 s88, 25
  s_cbranch_scc1 L_wsd_13
  s_add_u32 s55, s88, s89
  s_sub_u32 s56, s55, 40
  s_cselect_b32 s55, s55, s56
  s_lshl_b32 s56, s55, 11
  s_add_u32 m0, s56, 81920
  s_mul_i32 s55, s55, 27648
  s_add_u32 s55, s55, s87
  s_add_u32 s88, s88, 4
  buffer_load_dwordx4 v26, s[44:47], s55 offen  lds
  s_add_u32 m0, s56, 82944
  s_nop 0
  buffer_load_dwordx4 v27, s[48:51], s55 offen  lds
  s_cmp_ge_u32 s88, 25
  s_cbranch_scc1 L_wsd_13
  s_add_u32 s55, s88, s89
  s_sub_u32 s56, s55, 40
  s_cselect_b32 s55, s55, s56
  s_lshl_b32 s56, s55, 11
  s_add_u32 m0, s56, 81920
  s_mul_i32 s55, s55, 27648
  s_add_u32 s55, s55, s87
  s_add_u32 s88, s88, 4
  buffer_load_dwordx4 v26, s[44:47], s55 offen  lds
  s_add_u32 m0, s56, 82944
  s_nop 0
  buffer_load_dwordx4 v27, s[48:51], s55 offen  lds
  s_cmp_ge_u32 s88, 25
  s_cbranch_scc1 L_wsd_13
  s_add_u32 s55, s88, s89
  s_sub_u32 s56, s55, 40
  s_cselect_b32 s55, s55, s56
  s_lshl_b32 s56, s55, 11
  s_add_u32 m0, s56, 81920
  s_mul_i32 s55, s55, 27648
  s_add_u32 s55, s55, s87
  s_add_u32 s88, s88, 4
  buffer_load_dwordx4 v26, s[44:47], s55 offen  lds
  s_add_u32 m0, s56, 82944
  s_nop 0
  buffer_load_dwordx4 v27, s[48:51], s55 offen  lds
  s_cmp_ge_u32 s88, 25
  s_cbranch_scc1 L_wsd_13
  s_add_u32 s55, s88, s89
  s_sub_u32 s56, s55, 40
  s_cselect_b32 s55, s55, s56
  s_lshl_b32 s56, s55, 11
  s_add_u32 m0, s56, 81920
  s_mul_i32 s55, s55, 27648
  s_add_u32 s55, s55, s87
  s_add_u32 s88, s88, 4
  buffer_load_dwordx4 v26, s[44:47], s55 offen  lds
  s_add_u32 m0, s56, 82944
  s_nop 0
  buffer_load_dwordx4 v27, s[48:51], s55 offen  lds
L_wsd_13:
L_nokg_12:
  s_cmp_lt_u32 s36, 6
  s_cbranch_scc1 L_nomp_14
  s_cmp_ge_u32 s2, 240
  s_cbranch_scc1 L_nomp_14
  s_waitcnt vmcnt(10)
  v_lshlrev_b32 v76, 16, v216
  v_and_b32 v77, 0xffff0000, v216
  v_mul_f32 v68, v76, v140
  v_mul_f32 v69, v77, v140
  v_lshlrev_b32 v78, 16, v217
  v_and_b32 v79, 0xffff0000, v217
  v_mul_f32 v70, v78, v140
  v_mul_f32 v71, v79, v140
  v_lshlrev_b32 v76, 16, v218
  v_and_b32 v77, 0xffff0000, v218
  v_mul_f32 v72, v76, v140
  v_mul_f32 v73, v77, v140
  v_lshlrev_b32 v78, 16, v219
  v_and_b32 v79, 0xffff0000, v219
  v_mul_f32 v74, v78, v140
  v_mul_f32 v75, v79, v140
  s_waitcnt vmcnt(9)
  v_lshlrev_b32 v76, 16, v220
  v_and_b32 v77, 0xffff0000, v220
  v_fmac_f32 v68, v76, v141
  v_fmac_f32 v69, v77, v141
  v_lshlrev_b32 v78, 16, v221
  v_and_b32 v79, 0xffff0000, v221
  v_fmac_f32 v70, v78, v141
  v_fmac_f32 v71, v79, v141
  v_lshlrev_b32 v76, 16, v222
  v_and_b32 v77, 0xffff0000, v222
  v_fmac_f32 v72, v76, v141
  v_fmac_f32 v73, v77, v141
  v_lshlrev_b32 v78, 16, v223
  v_and_b32 v79, 0xffff0000, v223
  v_fmac_f32 v74, v78, v141
  v_fmac_f32 v75, v79, v141
  s_waitcnt vmcnt(8)
  v_lshlrev_b32 v76, 16, v224
  v_and_b32 v77, 0xffff0000, v224
  v_fmac_f32 v68, v76, v142
  v_fmac_f32 v69, v77, v142
  v_lshlrev_b32 v78, 16, v225
  v_and_b32 v79, 0xffff0000, v225
  v_fmac_f32 v70, v78, v142
  v_fmac_f32 v71, v79, v142
  v_lshlrev_b32 v76, 16, v226
  v_and_b32 v77, 0xffff0000, v226
  v_fmac_f32 v72, v76, v142
  v_fmac_f32 v73, v77, v142
  v_lshlrev_b32 v78, 16, v227
  v_and_b32 v79, 0xffff0000, v227
  v_fmac_f32 v74, v78, v142
  v_fmac_f32 v75, v79, v142
  s_waitcnt vmcnt(7)
  v_lshlrev_b32 v76, 16, v228
  v_and_b32 v77, 0xffff0000, v228
  v_fmac_f32 v68, v76, v143
  v_fmac_f32 v69, v77, v143
  v_lshlrev_b32 v78, 16, v229
  v_and_b32 v79, 0xffff0000, v229
  v_fmac_f32 v70, v78, v143
  v_fmac_f32 v71, v79, v143
  v_lshlrev_b32 v76, 16, v230
  v_and_b32 v77, 0xffff0000, v230
  v_fmac_f32 v72, v76, v143
  v_fmac_f32 v73, v77, v143
  v_lshlrev_b32 v78, 16, v231
  v_and_b32 v79, 0xffff0000, v231
  v_fmac_f32 v74, v78, v143
  v_fmac_f32 v75, v79, v143
  s_waitcnt vmcnt(6)
  v_lshlrev_b32 v76, 16, v232
  v_and_b32 v77, 0xffff0000, v232
  v_fmac_f32 v68, v76, v144
  v_fmac_f32 v69, v77, v144
  v_lshlrev_b32 v78, 16, v233
  v_and_b32 v79, 0xffff0000, v233
  v_fmac_f32 v70, v78, v144
  v_fmac_f32 v71, v79, v144
  v_lshlrev_b32 v76, 16, v234
  v_and_b32 v77, 0xffff0000, v234
  v_fmac_f32 v72, v76, v144
  v_fmac_f32 v73, v77, v144
  v_lshlrev_b32 v78, 16, v235
  v_and_b32 v79, 0xffff0000, v235
  v_fmac_f32 v74, v78, v144
  v_fmac_f32 v75, v79, v144
  s_waitcnt vmcnt(5)
  v_lshlrev_b32 v76, 16, v236
  v_and_b32 v77, 0xffff0000, v236
  v_fmac_f32 v68, v76, v145
  v_fmac_f32 v69, v77, v145
  v_lshlrev_b32 v78, 16, v237
  v_and_b32 v79, 0xffff0000, v237
  v_fmac_f32 v70, v78, v145
  v_fmac_f32 v71, v79, v145
  v_lshlrev_b32 v76, 16, v238
  v_and_b32 v77, 0xffff0000, v238
  v_fmac_f32 v72, v76, v145
  v_fmac_f32 v73, v77, v145
  v_lshlrev_b32 v78, 16, v239
  v_and_b32 v79, 0xffff0000, v239
  v_fmac_f32 v74, v78, v145
  v_fmac_f32 v75, v79, v145
  s_waitcnt vmcnt(4)
  v_lshlrev_b32 v76, 16, v240
  v_and_b32 v77, 0xffff0000, v240
  v_fmac_f32 v68, v76, v146
  v_fmac_f32 v69, v77, v146
  v_lshlrev_b32 v78, 16, v241
  v_and_b32 v79, 0xffff0000, v241
  v_fmac_f32 v70, v78, v146
  v_fmac_f32 v71, v79, v146
  v_lshlrev_b32 v76, 16, v242
  v_and_b32 v77, 0xffff0000, v242
  v_fmac_f32 v72, v76, v146
  v_fmac_f32 v73, v77, v146
  v_lshlrev_b32 v78, 16, v243
  v_and_b32 v79, 0xffff0000, v243
  v_fmac_f32 v74, v78, v146
  v_fmac_f32 v75, v79, v146
  s_waitcnt vmcnt(3)
  v_lshlrev_b32 v76, 16, v244
  v_and_b32 v77, 0xffff0000, v244
  v_fmac_f32 v68, v76, v147
  v_fmac_f32 v69, v77, v147
  v_lshlrev_b32 v78, 16, v245
  v_and_b32 v79, 0xffff0000, v245
  v_fmac_f32 v70, v78, v147
  v_fmac_f32 v71, v79, v147
  v_lshlrev_b32 v76, 16, v246
  v_and_b32 v77, 0xffff0000, v246
  v_fmac_f32 v72, v76, v147
  v_fmac_f32 v73, v77, v147
  v_lshlrev_b32 v78, 16, v247
  v_and_b32 v79, 0xffff0000, v247
  v_fmac_f32 v74, v78, v147
  v_fmac_f32 v75, v79, v147
  s_waitcnt vmcnt(2)
  v_lshlrev_b32 v76, 16, v248
  v_and_b32 v77, 0xffff0000, v248
  v_fmac_f32 v68, v76, v148
  v_fmac_f32 v69, v77, v148
  v_lshlrev_b32 v78, 16, v249
  v_and_b32 v79, 0xffff0000, v249
  v_fmac_f32 v70, v78, v148
  v_fmac_f32 v71, v79, v148
  v_lshlrev_b32 v76, 16, v250
  v_and_b32 v77, 0xffff0000, v250
  v_fmac_f32 v72, v76, v148
  v_fmac_f32 v73, v77, v148
  v_lshlrev_b32 v78, 16, v251
  v_and_b32 v79, 0xffff0000, v251
  v_fmac_f32 v74, v78, v148
  v_fmac_f32 v75, v79, v148
  s_waitcnt vmcnt(1)
  v_lshlrev_b32 v76, 16, v252
  v_and_b32 v77, 0xffff0000, v252
  v_fmac_f32 v68, v76, v149
  v_fmac_f32 v69, v77, v149
  v_lshlrev_b32 v78, 16, v253
  v_and_b32 v79, 0xffff0000, v253
  v_fmac_f32 v70, v78, v149
  v_fmac_f32 v71, v79, v149
  v_lshlrev_b32 v76, 16, v254
  v_and_b32 v77, 0xffff0000, v254
  v_fmac_f32 v72, v76, v149
  v_fmac_f32 v73, v77, v149
  v_lshlrev_b32 v78, 16, v255
  v_and_b32 v79, 0xffff0000, v255
  v_fmac_f32 v74, v78, v149
  v_fmac_f32 v75, v79, v149
  v_permlane32_swap_b32 v68, v72
  v_permlane32_swap_b32 v69, v73
  v_permlane32_swap_b32 v70, v74
  v_permlane32_swap_b32 v71, v75
  v_add_f32 v68, v68, v72
  v_add_f32 v69, v69, v73
  v_add_f32 v70, v70, v74
  v_add_f32 v71, v71, v75
  s_nop 0
  v_permlane16_swap_b32 v68, v70
  v_permlane16_swap_b32 v69, v71
  v_add_f32 v68, v68, v70
  v_add_f32 v69, v69, v71
  v_lshrrev_b32 v76, 4, v0
  v_and_b32 v77, 7, v0
  v_lshlrev_b32 v76, 3, v76
  v_lshl_add_u32 v76, v77, 5, v76
  v_add_f32_dpp v68, v68, v68 row_ror:8 row_mask:0xf bank_mask:0xf
  v_add_f32_dpp v69, v69, v69 row_ror:8 row_mask:0xf bank_mask:0xf
  v_or_b32 v68, 1, v68
  v_or_b32 v69, 1, v69
  s_mov_b32 exec_lo, 0x00ff00ff
  s_mov_b32 exec_hi, 0x00ff00ff
  buffer_store_dwordx2 v[68:69], v76, s[40:43], s69 offen sc1
  s_mov_b64 exec, -1
L_nomp_14:
  v_lshlrev_b32 v25, 16, v25
  v_cmp_eq_u32 s[58:59], 0, v208
  v_readlane_b32 s62, v25, 0
  v_readlane_b32 s63, v25, 1
  v_readlane_b32 s64, v25, 2
  v_mov_b32 v64, 0
  v_mov_b32 v65, 0
  v_mov_b32 v66, 0
  v_mov_b32 v67, 0
  v_lshlrev_b32 v35, 4, v0
  v_mov_b32 v54, s62
  v_cndmask_b32 v54, 0, v54, s[58:59]
  v_mov_b32 v55, s63
  v_cndmask_b32 v55, 0, v55, s[58:59]
  v_mov_b32 v56, s64
  v_cndmask_b32 v56, 0, v56, s[58:59]
  s_waitcnt lgkmcnt(0)
  s_barrier
  ds_read2st64_b32 v[176:177], v204 offset0:0 offset1:15
  ds_read2st64_b32 v[178:179], v205 offset0:0 offset1:15
  ds_read2st64_b32 v[180:181], v206 offset0:0 offset1:15
  ds_read2st64_b32 v[182:183], v207 offset0:0 offset1:15
  ds_read2st64_b32 v[184:185], v204 offset0:30 offset1:45
  ds_read2st64_b32 v[186:187], v205 offset0:30 offset1:45
  ds_read2st64_b32 v[188:189], v206 offset0:30 offset1:45
  ds_read2st64_b32 v[190:191], v207 offset0:30 offset1:45
  ds_read2st64_b32 v[192:193], v204 offset0:60 offset1:75
  ds_read2st64_b32 v[194:195], v205 offset0:60 offset1:75
  ds_read2st64_b32 v[196:197], v206 offset0:60 offset1:75
  ds_read2st64_b32 v[198:199], v207 offset0:60 offset1:75
  s_cmp_lg_u32 s36, 7
  s_cbranch_scc1 L_ow_15
  s_mov_b32 exec_lo, -1
  s_mov_b32 exec_hi, 0x3ff
  ds_write_b128 v35, v[64:67] offset:1024
  s_mov_b64 exec, 3
  ds_write_b128 v35, v[64:67] offset:27648
  ds_write_b128 v35, v[64:67] offset:31776
  ds_write_b128 v35, v[64:67] offset:35904
  s_mov_b64 exec, -1
L_ow_15:
  s_add_u32 s88, s36, 25
  s_cmp_ge_u32 s88, 40
  s_cbranch_scc1 L_wsd_16
  s_add_u32 s55, s88, s89
  s_sub_u32 s56, s55, 40
  s_cselect_b32 s55, s55, s56
  s_lshl_b32 s56, s55, 11
  s_add_u32 m0, s56, 81920
  s_mul_i32 s55, s55, 27648
  s_add_u32 s55, s55, s87
  s_add_u32 s88, s88, 8
  buffer_load_dwordx4 v26, s[44:47], s55 offen  lds
  s_add_u32 m0, s56, 82944
  s_nop 0
  buffer_load_dwordx4 v27, s[48:51], s55 offen  lds
  s_cmp_ge_u32 s88, 40
  s_cbranch_scc1 L_wsd_16
  s_add_u32 s55, s88, s89
  s_sub_u32 s56, s55, 40
  s_cselect_b32 s55, s55, s56
  s_lshl_b32 s56, s55, 11
  s_add_u32 m0, s56, 81920
  s_mul_i32 s55, s55, 27648
  s_add_u32 s55, s55, s87
  s_add_u32 s88, s88, 8
  buffer_load_dwordx4 v26, s[44:47], s55 offen  lds
  s_add_u32 m0, s56, 82944
  s_nop 0
  buffer_load_dwordx4 v27, s[48:51], s55 offen  lds
L_wsd_16:
  s_waitcnt lgkmcnt(11)
  v_add_f32 v36, v176, v177
  s_waitcnt lgkmcnt(10)
  v_add_f32 v37, v178, v179
  s_waitcnt lgkmcnt(9)
  v_add_f32 v38, v180, v181
  s_waitcnt lgkmcnt(8)
  v_add_f32 v39, v182, v183
  v_add_f32 v36, v36, v54
  s_waitcnt lgkmcnt(7)
  v_add_f32 v40, v184, v185
  s_waitcnt lgkmcnt(6)
  v_add_f32 v41, v186, v187
  s_waitcnt lgkmcnt(5)
  v_add_f32 v42, v188, v189
  s_waitcnt lgkmcnt(4)
  v_add_f32 v43, v190, v191
  v_add_f32 v40, v40, v55
  s_waitcnt lgkmcnt(3)
  v_add_f32 v44, v192, v193
  s_waitcnt lgkmcnt(2)
  v_add_f32 v45, v194, v195
  s_waitcnt lgkmcnt(1)
  v_add_f32 v46, v196, v197
  s_waitcnt lgkmcnt(0)
  v_add_f32 v47, v198, v199
  v_add_f32 v44, v44, v56
  v_cvt_pk_bf16_f32 v48, v36, v37
  v_cvt_pk_bf16_f32 v49, v38, v39
  ds_write_b64 v208, v[48:49] offset:27680
  v_cvt_pk_bf16_f32 v50, v40, v41
  v_cvt_pk_bf16_f32 v51, v42, v43
  ds_write_b64 v208, v[50:51] offset:31808
  v_cvt_pk_bf16_f32 v52, v44, v45
  v_cvt_pk_bf16_f32 v53, v46, v47
  ds_write_b64 v208, v[52:53] offset:35936
  s_cmp_lg_u32 s36, 0
  s_cbranch_scc1 L_ow_17
  global_load_dwordx4 v[68:71], v215, s[34:35] offset:0 sc1
  global_load_dwordx4 v[72:75], v215, s[34:35] offset:16 sc1
L_ow_17:
  v_add_f32 v37, v37, v36
  v_add_f32 v41, v41, v40
  v_add_f32 v45, v45, v44
  v_add_f32 v38, v38, v37
  v_add_f32 v42, v42, v41
  v_add_f32 v46, v46, v45
  v_add_f32 v39, v39, v38
  v_add_f32 v43, v43, v42
  v_add_f32 v47, v47, v46
  v_add_f32_dpp v54, v39, v39 row_shr:1 row_mask:0xf bank_mask:0xf bound_ctrl:0
  v_add_f32_dpp v55, v43, v43 row_shr:1 row_mask:0xf bank_mask:0xf bound_ctrl:0
  v_add_f32_dpp v56, v47, v47 row_shr:1 row_mask:0xf bank_mask:0xf bound_ctrl:0
  v_add_f32_dpp v54, v54, v54 row_shr:2 row_mask:0xf bank_mask:0xf bound_ctrl:0
  v_add_f32_dpp v55, v55, v55 row_shr:2 row_mask:0xf bank_mask:0xf bound_ctrl:0
  v_add_f32_dpp v56, v56, v56 row_shr:2 row_mask:0xf bank_mask:0xf bound_ctrl:0
  v_add_f32_dpp v54, v54, v54 row_shr:4 row_mask:0xf bank_mask:0xf bound_ctrl:0
  v_add_f32_dpp v55, v55, v55 row_shr:4 row_mask:0xf bank_mask:0xf bound_ctrl:0
  v_add_f32_dpp v56, v56, v56 row_shr:4 row_mask:0xf bank_mask:0xf bound_ctrl:0
  v_add_f32_dpp v54, v54, v54 row_shr:8 row_mask:0xf bank_mask:0xf bound_ctrl:0
  v_add_f32_dpp v55, v55, v55 row_shr:8 row_mask:0xf bank_mask:0xf bound_ctrl:0
  v_add_f32_dpp v56, v56, v56 row_shr:8 row_mask:0xf bank_mask:0xf bound_ctrl:0
  v_add_f32_dpp v54, v54, v54 row_bcast:15 row_mask:0xa bank_mask:0xf
  v_add_f32_dpp v55, v55, v55 row_bcast:15 row_mask:0xa bank_mask:0xf
  v_add_f32_dpp v56, v56, v56 row_bcast:15 row_mask:0xa bank_mask:0xf
  v_add_f32_dpp v54, v54, v54 row_bcast:31 row_mask:0xc bank_mask:0xf
  v_add_f32_dpp v55, v55, v55 row_bcast:31 row_mask:0xc bank_mask:0xf
  v_add_f32_dpp v56, v56, v56 row_bcast:31 row_mask:0xc bank_mask:0xf
  s_lshl_b32 s55, s36, 2
  s_add_u32 s55, s55, 81408
  v_mov_b32 v33, s55
  s_mov_b32 exec_lo, 0
  s_brev_b32 exec_hi, 1
  ds_write_b32 v33, v54 offset:0
  ds_write_b32 v33, v55 offset:32
  ds_write_b32 v33, v56 offset:64
  s_mov_b64 exec, -1
  s_lshl_b32 s55, s36, 2
  s_lshr_b32 s65, 0x98402b73, s55
  v_lshlrev_b32 v7, 4, v0
  s_cmp_lt_u32 s36, 4
  s_mov_b32 s55, 606084378
  s_cmov_b32 s55, 353240832
  s_mov_b32 s56, 656613148
  s_cmov_b32 s56, 420744454
  s_and_b32 s57, s36, 3
  s_lshl_b32 s57, s57, 3
  s_lshr_b32 s55, s55, s57
  s_lshr_b32 s56, s56, s57
  s_and_b32 s55, s55, 0xff
  s_and_b32 s56, s56, 0xff
  s_lshl_b32 s96, s55, 11
  s_add_u32 s96, s96, 81920
  s_lshl_b32 s98, s56, 11
  s_add_u32 s98, s98, 81920
  s_add_u32 s55, s55, 40
  s_mul_i32 s97, s55, 27648
  s_add_u32 s56, s56, 40
  s_mul_i32 s99, s56, 27648
  s_and_b32 s66, s65, 3
  s_bfe_u32 s67, s65, 0x20002
  s_mul_i32 s55, s66, 3072
  s_lshl_b32 s56, s67, 4
  s_add_u32 s55, s55, s56
  v_add_u32 v3, s55, v1
  v_add_u32 v8, s55, v5
  s_mul_i32 s56, s67, 4128
  v_add_u32 v4, s56, v2
  s_lshl_b32 s55, s67, 13
  s_lshl_b32 s56, s66, 11
  s_add_u32 s55, s55, s56
  s_add_u32 s55, s55, 40032
  v_lshl_add_u32 v6, v0, 2, s55
  s_add_u32 s56, s56, 13984
  v_lshl_add_u32 v22, v0, 2, s56
  s_lshl_b32 s60, s36, 10
  s_mov_b32 s57, 1048576
  s_mov_b32 s58, 122880
  s_cmp_lg_u32 s36, 0
  s_cbranch_scc1 L_ow_18
  s_waitcnt vmcnt(1)
  v_min3_u32 v76, v68, v69, v70
  v_max3_u32 v77, v68, v69, v70
  s_waitcnt vmcnt(0)
  v_min3_u32 v76, v76, v71, v72
  v_max3_u32 v77, v77, v71, v72
  v_min3_u32 v76, v76, v73, v74
  v_max3_u32 v77, v77, v73, v74
  v_min_u32 v76, v76, v75
  v_max_u32 v77, v77, v75
  v_xor_b32 v76, s93, v76
  v_xor_b32 v77, s93, v77
  v_or_b32 v76, v76, v77
  v_cmp_ne_u32 vcc, 0, v76
  s_nop 0
  s_cbranch_vccz L_p1d_20
L_p1_19:
  global_load_dwordx4 v[68:71], v215, s[34:35] offset:0 sc1
  global_load_dwordx4 v[72:75], v215, s[34:35] offset:16 sc1
  s_waitcnt vmcnt(1)
  v_min3_u32 v76, v68, v69, v70
  v_max3_u32 v77, v68, v69, v70
  s_waitcnt vmcnt(0)
  v_min3_u32 v76, v76, v71, v72
  v_max3_u32 v77, v77, v71, v72
  v_min3_u32 v76, v76, v73, v74
  v_max3_u32 v77, v77, v73, v74
  v_min_u32 v76, v76, v75
  v_max_u32 v77, v77, v75
  v_xor_b32 v76, s93, v76
  v_xor_b32 v77, s93, v77
  v_or_b32 v76, v76, v77
  v_cmp_ne_u32 vcc, 0, v76
  s_nop 0
  s_cbranch_vccz L_p1d_20
  s_sleep 2
  s_add_u32 s79, s79, 1
  s_cmp_lt_u32 s79, 400000
  s_cbranch_scc1 L_p1_19
L_p1d_20:
L_ow_18:
  s_waitcnt vmcnt(0) lgkmcnt(0)
  s_barrier
  s_add_u32 m0, s60, 1696
  s_nop 0
  buffer_load_dwordx4 v210, s[40:43], s57 offen sc1 lds
  s_cmp_ge_u32 s36, 4
  s_cbranch_scc1 L_x2_21
  s_add_u32 m0, s60, 9888
  s_nop 0
  buffer_load_dwordx4 v211, s[40:43], s57 offen sc1 lds
L_x2_21:
  s_add_u32 m0, s60, 13984
  s_nop 0
  buffer_load_dwordx4 v212, s[40:43], s58 offen sc1 lds
  v_min_u32 v33, 23, v0
  v_lshlrev_b32 v33, 2, v33
  v_add_u32 v33, 81408, v33
  ds_read_b32 v34, v33
  v_and_b32 v33, 7, v0
  v_cmp_gt_u32 vcc, s36, v33
  v_sub_f32 v54, v54, v39
  v_sub_f32 v55, v55, v43
  v_sub_f32 v56, v56, v47
  s_waitcnt lgkmcnt(0)
  v_cndmask_b32 v34, 0, v34, vcc
  s_nop 1
  v_add_f32_dpp v34, v34, v34 row_shr:1 row_mask:0xf bank_mask:0xf bound_ctrl:0
  s_nop 1
  v_add_f32_dpp v34, v34, v34 row_shr:2 row_mask:0xf bank_mask:0xf bound_ctrl:0
  s_nop 1
  v_add_f32_dpp v34, v34, v34 row_shr:4 row_mask:0xf bank_mask:0xf bound_ctrl:0
  s_nop 0
  v_readlane_b32 s62, v34, 7
  v_readlane_b32 s63, v34, 15
  v_readlane_b32 s64, v34, 23
  v_add_f32 v54, s62, v54
  v_add_f32 v36, v36, v54
  v_add_f32 v37, v37, v54
  v_add_f32 v38, v38, v54
  v_add_f32 v39, v39, v54
  ds_write_b128 v209, v[36:39] offset:40032
  v_add_f32 v55, s63, v55
  v_add_f32 v40, v40, v55
  v_add_f32 v41, v41, v55
  v_add_f32 v42, v42, v55
  v_add_f32 v43, v43, v55
  ds_write_b128 v209, v[40:43] offset:48224
  v_add_f32 v56, s64, v56
  v_add_f32 v44, v44, v56
  v_add_f32 v45, v45, v56
  v_add_f32 v46, v46, v56
  v_add_f32 v47, v47, v56
  ds_write_b128 v209, v[44:47] offset:56416
  ds_read_b64_tr_b16 v[96:97], v213 offset:0
  ds_read_b64_tr_b16 v[98:99], v213 offset:512
  ds_read_b64_tr_b16 v[100:101], v213 offset:4096
  ds_read_b64_tr_b16 v[102:103], v213 offset:4608
  ds_read_b64_tr_b16 v[104:105], v213 offset:8192
  ds_read_b64_tr_b16 v[106:107], v213 offset:8704
  ds_read_b64_tr_b16 v[108:109], v213 offset:12288
  ds_read_b64_tr_b16 v[110:111], v213 offset:12800
  ds_read_b64_tr_b16 v[112:113], v213 offset:16384
  ds_read_b64_tr_b16 v[114:115], v213 offset:16896
  ds_read_b64_tr_b16 v[116:117], v213 offset:20480
  ds_read_b64_tr_b16 v[118:119], v213 offset:20992
  ds_read_b64_tr_b16 v[120:121], v213 offset:24576
  ds_read_b64_tr_b16 v[122:123], v213 offset:25088
  ds_read_b64_tr_b16 v[124:125], v213 offset:28672
  ds_read_b64_tr_b16 v[126:127], v213 offset:29184
  ds_read_b64_tr_b16 v[128:129], v213 offset:32768
  ds_read_b64_tr_b16 v[130:131], v213 offset:33280
  ds_read_b64_tr_b16 v[132:133], v213 offset:36864
  ds_read_b64_tr_b16 v[134:135], v213 offset:37376
  ds_read_b64_tr_b16 v[136:137], v214 offset:0
  ds_read_b64_tr_b16 v[138:139], v214 offset:512
  ds_read_b64_tr_b16 v[140:141], v214 offset:4096
  ds_read_b64_tr_b16 v[142:143], v214 offset:4608
  ds_read_b64_tr_b16 v[144:145], v214 offset:8192
  ds_read_b64_tr_b16 v[146:147], v214 offset:8704
  ds_read_b64_tr_b16 v[148:149], v214 offset:12288
  ds_read_b64_tr_b16 v[150:151], v214 offset:12800
  ds_read_b64_tr_b16 v[152:153], v214 offset:16384
  ds_read_b64_tr_b16 v[154:155], v214 offset:16896
  ds_read_b64_tr_b16 v[156:157], v214 offset:20480
  ds_read_b64_tr_b16 v[158:159], v214 offset:20992
  ds_read_b64_tr_b16 v[160:161], v214 offset:24576
  ds_read_b64_tr_b16 v[162:163], v214 offset:25088
  ds_read_b64_tr_b16 v[164:165], v214 offset:28672
  ds_read_b64_tr_b16 v[166:167], v214 offset:29184
  ds_read_b64_tr_b16 v[168:169], v214 offset:32768
  ds_read_b64_tr_b16 v[170:171], v214 offset:33280
  ds_read_b64_tr_b16 v[172:173], v214 offset:36864
  ds_read_b64_tr_b16 v[174:175], v214 offset:37376
  s_waitcnt vmcnt(0) lgkmcnt(0)
  s_cmp_ge_u32 s36, 4
  s_cbranch_scc1 L_cy_22
  s_barrier
  ds_read_b64_tr_b16 v[64:65], v4 offset:32
  ds_read_b64_tr_b16 v[66:67], v4 offset:0
  ds_read_b64_tr_b16 v[60:61], v3 offset:2688
  ds_read_b64_tr_b16 v[62:63], v3 offset:2784
  ds_read_b64_tr_b16 v[56:57], v3 offset:2304
  ds_read_b64_tr_b16 v[58:59], v3 offset:2400
  ds_read_b64_tr_b16 v[52:53], v3 offset:1920
  ds_read_b64_tr_b16 v[54:55], v3 offset:2016
  ds_read_b64_tr_b16 v[48:49], v3 offset:1536
  ds_read_b64_tr_b16 v[50:51], v3 offset:1632
  ds_read_b64_tr_b16 v[44:45], v3 offset:1152
  ds_read_b64_tr_b16 v[46:47], v3 offset:1248
  ds_read_b64_tr_b16 v[40:41], v3 offset:768
  ds_read_b64_tr_b16 v[42:43], v3 offset:864
  ds_read_b64_tr_b16 v[36:37], v3 offset:384
  ds_read_b64_tr_b16 v[38:39], v3 offset:480
  ds_read_b64_tr_b16 v[32:33], v3 offset:0
  ds_read_b64_tr_b16 v[34:35], v3 offset:96
  ds_read_b64_tr_b16 v[68:69], v4 offset:288
  ds_read_b64_tr_b16 v[70:71], v4 offset:256
  v_subrev_u32 v11, 768, v3
  v_subrev_u32 v3, 3840, v3
  v_mov_b32 v208, 0
  v_mov_b32 v209, 0
  v_mov_b32 v210, 0
  v_mov_b32 v211, 0
  s_mov_b32 s68, s66
  s_waitcnt lgkmcnt(15)
  v_mfma_f32_16x16x32_bf16 v[204:207], v[60:63], v[64:67], 0
  ds_read_b64_tr_b16 v[72:73], v4 offset:544
  s_waitcnt lgkmcnt(15)
  v_mfma_f32_16x16x32_bf16 v[200:203], v[56:59], v[64:67], 0
  ds_read_b64_tr_b16 v[74:75], v4 offset:512
  s_waitcnt lgkmcnt(14)
  v_mfma_f32_16x16x32_bf16 v[196:199], v[52:55], v[64:67], 0
  ds_read_b64_tr_b16 v[60:61], v11 offset:384
  s_waitcnt lgkmcnt(13)
  v_mfma_f32_16x16x32_bf16 v[192:195], v[48:51], v[64:67], 0
  ds_read_b64_tr_b16 v[62:63], v11 offset:480
  s_waitcnt lgkmcnt(12)
  v_mfma_f32_16x16x32_bf16 v[188:191], v[44:47], v[64:67], 0
  ds_read_b64_tr_b16 v[56:57], v11 offset:0
  s_waitcnt lgkmcnt(11)
  v_mfma_f32_16x16x32_bf16 v[184:187], v[40:43], v[64:67], 0
  ds_read_b64_tr_b16 v[58:59], v11 offset:96
  s_waitcnt lgkmcnt(10)
  v_mfma_f32_16x16x32_bf16 v[180:183], v[36:39], v[64:67], 0
  s_waitcnt lgkmcnt(8)
  v_mfma_f32_16x16x32_bf16 v[176:179], v[32:35], v[64:67], 0
L_cl_24:
  s_waitcnt lgkmcnt(6)
  v_mfma_f32_16x16x32_bf16 v[204:207], v[52:55], v[68:71], v[204:207]
  ds_read_b64_tr_b16 v[76:77], v4 offset:800
  v_mfma_f32_16x16x32_bf16 v[200:203], v[48:51], v[68:71], v[200:203]
  ds_read_b64_tr_b16 v[78:79], v4 offset:768
  v_mfma_f32_16x16x32_bf16 v[196:199], v[44:47], v[68:71], v[196:199]
  ds_read_b64_tr_b16 v[52:53], v3 offset:2688
  v_mfma_f32_16x16x32_bf16 v[192:195], v[40:43], v[68:71], v[192:195]
  ds_read_b64_tr_b16 v[54:55], v3 offset:2784
  v_mfma_f32_16x16x32_bf16 v[188:191], v[36:39], v[68:71], v[188:191]
  ds_read_b64_tr_b16 v[48:49], v3 offset:2304
  v_mfma_f32_16x16x32_bf16 v[184:187], v[32:35], v[68:71], v[184:187]
  ds_read_b64_tr_b16 v[50:51], v3 offset:2400
  s_waitcnt lgkmcnt(8)
  v_mfma_f32_16x16x32_bf16 v[180:183], v[60:63], v[68:71], v[180:183]
  s_mov_b32 m0, s96
  s_nop 0
  buffer_load_dwordx4 v26, s[44:47], s97 offen lds
  s_waitcnt lgkmcnt(6)
  v_mfma_f32_16x16x32_bf16 v[176:179], v[56:59], v[68:71], v[176:179]
  v_mfma_f32_16x16x32_bf16 v[208:211], v[60:63], v[64:67], v[208:211]
  v_mfma_f32_16x16x32_bf16 v[204:207], v[44:47], v[72:75], v[204:207]
  ds_read_b64_tr_b16 v[64:65], v4 offset:1056
  v_mfma_f32_16x16x32_bf16 v[200:203], v[40:43], v[72:75], v[200:203]
  ds_read_b64_tr_b16 v[66:67], v4 offset:1024
  v_mfma_f32_16x16x32_bf16 v[196:199], v[36:39], v[72:75], v[196:199]
  ds_read_b64_tr_b16 v[44:45], v3 offset:1920
  v_mfma_f32_16x16x32_bf16 v[192:195], v[32:35], v[72:75], v[192:195]
  ds_read_b64_tr_b16 v[46:47], v3 offset:2016
  v_mfma_f32_16x16x32_bf16 v[188:191], v[60:63], v[72:75], v[188:191]
  ds_read_b64_tr_b16 v[40:41], v3 offset:1536
  v_mfma_f32_16x16x32_bf16 v[184:187], v[56:59], v[72:75], v[184:187]
  ds_read_b64_tr_b16 v[42:43], v3 offset:1632
  s_waitcnt lgkmcnt(8)
  v_mfma_f32_16x16x32_bf16 v[180:183], v[52:55], v[72:75], v[180:183]
  s_add_u32 m0, s96, 1024
  s_add_u32 s96, s96, 2048
  buffer_load_dwordx4 v27, s[48:51], s97 offen lds
  s_add_u32 s97, s97, 27648
  s_min_u32 s96, s96, s98
  s_min_u32 s97, s97, s99
  s_waitcnt lgkmcnt(6)
  v_mfma_f32_16x16x32_bf16 v[176:179], v[48:51], v[72:75], v[176:179]
  global_load_dword v17, v88, s[34:35] sc1
  global_load_dword v23, v88, s[34:35] offset:1024 sc1
  v_mfma_f32_16x16x32_bf16 v[208:211], v[52:55], v[68:71], v[208:211]
  v_mfma_f32_16x16x32_bf16 v[204:207], v[36:39], v[76:79], v[204:207]
  ds_read_b64_tr_b16 v[68:69], v4 offset:1312
  v_mfma_f32_16x16x32_bf16 v[200:203], v[32:35], v[76:79], v[200:203]
  ds_read_b64_tr_b16 v[70:71], v4 offset:1280
  v_mfma_f32_16x16x32_bf16 v[196:199], v[60:63], v[76:79], v[196:199]
  ds_read_b64_tr_b16 v[36:37], v3 offset:1152
  v_mfma_f32_16x16x32_bf16 v[192:195], v[56:59], v[76:79], v[192:195]
  ds_read_b64_tr_b16 v[38:39], v3 offset:1248
  v_mfma_f32_16x16x32_bf16 v[188:191], v[52:55], v[76:79], v[188:191]
  ds_read_b64_tr_b16 v[32:33], v3 offset:768
  v_mfma_f32_16x16x32_bf16 v[184:187], v[48:51], v[76:79], v[184:187]
  ds_read_b64_tr_b16 v[34:35], v3 offset:864
  s_waitcnt lgkmcnt(8)
  v_mfma_f32_16x16x32_bf16 v[180:183], v[44:47], v[76:79], v[180:183]
  s_mov_b32 m0, s96
  s_nop 0
  buffer_load_dwordx4 v26, s[44:47], s97 offen lds
  s_waitcnt lgkmcnt(6)
  v_mfma_f32_16x16x32_bf16 v[176:179], v[40:43], v[76:79], v[176:179]
  v_mfma_f32_16x16x32_bf16 v[208:211], v[44:47], v[72:75], v[208:211]
  v_mfma_f32_16x16x32_bf16 v[204:207], v[60:63], v[64:67], v[204:207]
  ds_read_b64_tr_b16 v[72:73], v4 offset:1568
  v_mfma_f32_16x16x32_bf16 v[200:203], v[56:59], v[64:67], v[200:203]
  ds_read_b64_tr_b16 v[74:75], v4 offset:1536
  v_mfma_f32_16x16x32_bf16 v[196:199], v[52:55], v[64:67], v[196:199]
  ds_read_b64_tr_b16 v[60:61], v3 offset:384
  v_mfma_f32_16x16x32_bf16 v[192:195], v[48:51], v[64:67], v[192:195]
  ds_read_b64_tr_b16 v[62:63], v3 offset:480
  v_mfma_f32_16x16x32_bf16 v[188:191], v[44:47], v[64:67], v[188:191]
  ds_read_b64_tr_b16 v[56:57], v3 offset:0
  v_mfma_f32_16x16x32_bf16 v[184:187], v[40:43], v[64:67], v[184:187]
  ds_read_b64_tr_b16 v[58:59], v3 offset:96
  s_waitcnt lgkmcnt(8)
  v_mfma_f32_16x16x32_bf16 v[180:183], v[36:39], v[64:67], v[180:183]
  s_add_u32 m0, s96, 1024
  s_add_u32 s96, s96, 2048
  buffer_load_dwordx4 v27, s[48:51], s97 offen lds
  s_add_u32 s97, s97, 27648
  s_min_u32 s96, s96, s98
  s_min_u32 s97, s97, s99
  s_waitcnt lgkmcnt(6)
  v_mfma_f32_16x16x32_bf16 v[176:179], v[32:35], v[64:67], v[176:179]
  s_sub_u32 s68, s68, 1
  v_subrev_u32 v3, 3072, v3
  v_add_u32 v4, 1024, v4
  v_mfma_f32_16x16x32_bf16 v[208:211], v[36:39], v[76:79], v[208:211]
  s_cmp_lg_u32 s68, 0
  s_cbranch_scc1 L_cl_24
L_ct_25:
  global_load_dwordx2 v[12:13], v90, s[34:35] sc1
  global_load_dwordx2 v[14:15], v90, s[34:35] offset:2560 sc1
  v_mfma_f32_16x16x32_bf16 v[204:207], v[52:55], v[68:71], v[204:207]
  ds_read_b64_tr_b16 v[76:77], v4 offset:800
  v_mfma_f32_16x16x32_bf16 v[200:203], v[48:51], v[68:71], v[200:203]
  ds_read_b64_tr_b16 v[78:79], v4 offset:768
  v_mfma_f32_16x16x32_bf16 v[196:199], v[44:47], v[68:71], v[196:199]
  s_mov_b32 m0, s96
  s_nop 0
  buffer_load_dwordx4 v26, s[44:47], s97 offen lds
  v_mfma_f32_16x16x32_bf16 v[192:195], v[40:43], v[68:71], v[192:195]
  v_mfma_f32_16x16x32_bf16 v[188:191], v[36:39], v[68:71], v[188:191]
  s_add_u32 m0, s96, 1024
  s_add_u32 s96, s96, 2048
  buffer_load_dwordx4 v27, s[48:51], s97 offen lds
  s_add_u32 s97, s97, 27648
  s_min_u32 s96, s96, s98
  s_min_u32 s97, s97, s99
  v_mfma_f32_16x16x32_bf16 v[184:187], v[32:35], v[68:71], v[184:187]
  ds_read_b64_tr_b16 v[212:213], v8
  ds_read_b64_tr_b16 v[214:215], v8 offset:1536
  ds_read2st64_b32 v[216:217], v6 offset0:0 offset1:1
  ds_read2st64_b32 v[218:219], v6 offset0:2 offset1:3
  ds_read2st64_b32 v[220:221], v6 offset0:4 offset1:5
  ds_read2st64_b32 v[222:223], v6 offset0:6 offset1:7
  ds_read2st64_b32 v[244:245], v22 offset0:0 offset1:1
  ds_read2st64_b32 v[246:247], v22 offset0:2 offset1:3
  ds_read2st64_b32 v[248:249], v22 offset0:4 offset1:5
  ds_read2st64_b32 v[250:251], v22 offset0:6 offset1:7
  s_waitcnt lgkmcnt(15)
  v_mfma_f32_16x16x32_bf16 v[204:207], v[44:47], v[72:75], v[204:207]
  v_mfma_f32_16x16x32_bf16 v[200:203], v[40:43], v[72:75], v[200:203]
  v_mfma_f32_16x16x32_bf16 v[196:199], v[36:39], v[72:75], v[196:199]
  v_mfma_f32_16x16x32_bf16 v[192:195], v[32:35], v[72:75], v[192:195]
  s_waitcnt lgkmcnt(10)
  v_mfma_f32_16x16x32_bf16 v[204:207], v[36:39], v[76:79], v[204:207]
  s_waitcnt lgkmcnt(9)
  v_lshlrev_b32 v235, 16, v212
  s_waitcnt lgkmcnt(3)
  v_and_b32 v225, 0xffff0000, v244
  v_lshlrev_b32 v244, 16, v244
  v_fmac_f32 v244, v235, v225
  v_and_b32 v236, 0xffff0000, v212
  v_and_b32 v226, 0xffff0000, v245
  v_lshlrev_b32 v245, 16, v245
  v_fmac_f32 v245, v236, v226
  v_lshlrev_b32 v237, 16, v213
  s_waitcnt lgkmcnt(2)
  v_and_b32 v227, 0xffff0000, v246
  v_lshlrev_b32 v246, 16, v246
  v_fmac_f32 v246, v237, v227
  v_and_b32 v238, 0xffff0000, v213
  v_and_b32 v228, 0xffff0000, v247
  v_lshlrev_b32 v247, 16, v247
  v_fmac_f32 v247, v238, v228
  v_mfma_f32_16x16x32_bf16 v[200:203], v[32:35], v[76:79], v[200:203]
  v_lshlrev_b32 v239, 16, v214
  s_waitcnt lgkmcnt(1)
  v_and_b32 v229, 0xffff0000, v248
  v_lshlrev_b32 v248, 16, v248
  v_fmac_f32 v248, v239, v229
  v_and_b32 v240, 0xffff0000, v214
  v_and_b32 v230, 0xffff0000, v249
  v_lshlrev_b32 v249, 16, v249
  v_fmac_f32 v249, v240, v230
  v_lshlrev_b32 v241, 16, v215
  s_waitcnt lgkmcnt(0)
  v_and_b32 v231, 0xffff0000, v250
  v_lshlrev_b32 v250, 16, v250
  v_fmac_f32 v250, v241, v231
  v_and_b32 v242, 0xffff0000, v215
  v_and_b32 v232, 0xffff0000, v251
  v_lshlrev_b32 v251, 16, v251
  v_fmac_f32 v251, v242, v232
  s_add_u32 s58, s52, s67
  s_mul_i32 s58, s58, 4224
  s_lshl_b32 s59, s66, 10
  s_add_u32 s58, s58, s59
  s_add_u32 s59, s58, 10485760
  s_add_u32 s58, s58, 7340032
  v_add_f32_dpp v224, v211, v210 wave_shr:1 row_mask:0xf bank_mask:0xf bound_ctrl:0
  v_add_f32_dpp v225, v211, v178 wave_ror:1 row_mask:0xf bank_mask:0xf
  v_add_f32_dpp v226, v179, v182 wave_ror:1 row_mask:0xf bank_mask:0xf
  v_add_f32_dpp v227, v183, v186 wave_ror:1 row_mask:0xf bank_mask:0xf
  v_add_f32_dpp v228, v187, v190 wave_ror:1 row_mask:0xf bank_mask:0xf
  v_add_f32_dpp v229, v191, v194 wave_ror:1 row_mask:0xf bank_mask:0xf
  v_add_f32_dpp v230, v195, v198 wave_ror:1 row_mask:0xf bank_mask:0xf
  v_add_f32_dpp v231, v199, v202 wave_ror:1 row_mask:0xf bank_mask:0xf
  v_add_f32_dpp v232, v203, v206 wave_ror:1 row_mask:0xf bank_mask:0xf
  v_add_f32_dpp v225, v179, v178 wave_shr:1 row_mask:0xf bank_mask:0xf
  v_add_f32_dpp v226, v183, v182 wave_shr:1 row_mask:0xf bank_mask:0xf
  v_add_f32_dpp v227, v187, v186 wave_shr:1 row_mask:0xf bank_mask:0xf
  v_add_f32_dpp v228, v191, v190 wave_shr:1 row_mask:0xf bank_mask:0xf
  v_add_f32_dpp v229, v195, v194 wave_shr:1 row_mask:0xf bank_mask:0xf
  v_add_f32_dpp v230, v199, v198 wave_shr:1 row_mask:0xf bank_mask:0xf
  v_add_f32_dpp v231, v203, v202 wave_shr:1 row_mask:0xf bank_mask:0xf
  v_add_f32_dpp v232, v207, v206 wave_shr:1 row_mask:0xf bank_mask:0xf
  v_add_f32_dpp v234, v224, v209 wave_shr:1 row_mask:0xf bank_mask:0xf bound_ctrl:0
  v_add_f32_dpp v235, v224, v177 wave_ror:1 row_mask:0xf bank_mask:0xf
  v_add_f32_dpp v236, v225, v181 wave_ror:1 row_mask:0xf bank_mask:0xf
  v_add_f32_dpp v237, v226, v185 wave_ror:1 row_mask:0xf bank_mask:0xf
  v_add_f32_dpp v238, v227, v189 wave_ror:1 row_mask:0xf bank_mask:0xf
  v_add_f32_dpp v239, v228, v193 wave_ror:1 row_mask:0xf bank_mask:0xf
  v_add_f32_dpp v240, v229, v197 wave_ror:1 row_mask:0xf bank_mask:0xf
  v_add_f32_dpp v241, v230, v201 wave_ror:1 row_mask:0xf bank_mask:0xf
  v_add_f32_dpp v242, v231, v205 wave_ror:1 row_mask:0xf bank_mask:0xf
  v_add_f32_dpp v235, v225, v177 wave_shr:1 row_mask:0xf bank_mask:0xf
  v_add_f32_dpp v236, v226, v181 wave_shr:1 row_mask:0xf bank_mask:0xf
  v_add_f32_dpp v237, v227, v185 wave_shr:1 row_mask:0xf bank_mask:0xf
  v_add_f32_dpp v238, v228, v189 wave_shr:1 row_mask:0xf bank_mask:0xf
  v_add_f32_dpp v239, v229, v193 wave_shr:1 row_mask:0xf bank_mask:0xf
  v_add_f32_dpp v240, v230, v197 wave_shr:1 row_mask:0xf bank_mask:0xf
  v_add_f32_dpp v241, v231, v201 wave_shr:1 row_mask:0xf bank_mask:0xf
  v_add_f32_dpp v242, v232, v205 wave_shr:1 row_mask:0xf bank_mask:0xf
  v_add_f32_dpp v179, v234, v176 wave_ror:1 row_mask:0xf bank_mask:0xf
  v_add_f32_dpp v183, v235, v180 wave_ror:1 row_mask:0xf bank_mask:0xf
  v_add_f32_dpp v187, v236, v184 wave_ror:1 row_mask:0xf bank_mask:0xf
  v_add_f32_dpp v191, v237, v188 wave_ror:1 row_mask:0xf bank_mask:0xf
  v_add_f32_dpp v195, v238, v192 wave_ror:1 row_mask:0xf bank_mask:0xf
  v_add_f32_dpp v199, v239, v196 wave_ror:1 row_mask:0xf bank_mask:0xf
  v_add_f32_dpp v203, v240, v200 wave_ror:1 row_mask:0xf bank_mask:0xf
  v_add_f32_dpp v207, v241, v204 wave_ror:1 row_mask:0xf bank_mask:0xf
  v_add_f32_dpp v179, v235, v176 wave_shr:1 row_mask:0xf bank_mask:0xf
  v_add_f32_dpp v183, v236, v180 wave_shr:1 row_mask:0xf bank_mask:0xf
  v_add_f32_dpp v187, v237, v184 wave_shr:1 row_mask:0xf bank_mask:0xf
  v_add_f32_dpp v191, v238, v188 wave_shr:1 row_mask:0xf bank_mask:0xf
  v_add_f32_dpp v195, v239, v192 wave_shr:1 row_mask:0xf bank_mask:0xf
  v_add_f32_dpp v199, v240, v196 wave_shr:1 row_mask:0xf bank_mask:0xf
  v_add_f32_dpp v203, v241, v200 wave_shr:1 row_mask:0xf bank_mask:0xf
  v_add_f32_dpp v207, v242, v204 wave_shr:1 row_mask:0xf bank_mask:0xf
  s_waitcnt vmcnt(6)
  v_min_u32 v16, v17, v23
  v_cmp_eq_u32 vcc, 0, v16
  s_nop 0
  s_cbranch_vccz L_md_27
L_mr_26:
  global_load_dword v17, v88, s[34:35] sc1
  global_load_dword v23, v88, s[34:35] offset:1024 sc1
  s_waitcnt vmcnt(0)
  v_min_u32 v16, v17, v23
  v_cmp_eq_u32 vcc, 0, v16
  s_nop 0
  s_cbranch_vccz L_md_27
  s_sleep 2
  s_add_u32 s79, s79, 1
  s_cmp_lt_u32 s79, 400000
  s_cbranch_scc1 L_mr_26
L_md_27:
  v_add_f32 v17, v17, v23
  s_nop 1
  v_add_f32_dpp v17, v17, v17 quad_perm:[1,0,3,2] row_mask:0xf bank_mask:0xf
  s_nop 1
  v_add_f32_dpp v17, v17, v17 quad_perm:[2,3,0,1] row_mask:0xf bank_mask:0xf
  v_cvt_pk_bf16_f32 v17, v17, v17
  v_lshlrev_b32 v17, 16, v17
  v_add_f32 v16, 1.0, v17
  v_cvt_pk_bf16_f32 v16, v16, v16
  v_lshlrev_b32 v16, 16, v16
  v_readlane_b32 s55, v17, 24
  v_readlane_b32 s72, v16, 36
  s_nop 0
  v_mul_f32 v18, s55, v16
  v_mul_f32 v19, s55, v17
  v_readlane_b32 s70, v18, 12
  v_readlane_b32 s71, v19, 0
  v_readlane_b32 s55, v17, 28
  v_readlane_b32 s75, v16, 40
  s_nop 0
  v_mul_f32 v18, s55, v16
  v_mul_f32 v19, s55, v17
  v_readlane_b32 s73, v18, 16
  v_readlane_b32 s74, v19, 4
  v_readlane_b32 s55, v17, 32
  v_readlane_b32 s78, v16, 44
  s_nop 0
  v_mul_f32 v18, s55, v16
  v_mul_f32 v19, s55, v17
  v_readlane_b32 s76, v18, 20
  v_readlane_b32 s77, v19, 8
  s_cmp_eq_u32 s67, 1
  s_cselect_b32 s55, s73, s70
  s_cselect_b32 s56, s74, s71
  s_cselect_b32 s57, s75, s72
  s_cmp_eq_u32 s67, 2
  s_cselect_b32 s55, s76, s55
  s_cselect_b32 s56, s77, s56
  s_cselect_b32 s57, s78, s57
  v_fmac_f32 v244, s56, v216
  v_fmac_f32 v245, s56, v217
  v_fmac_f32 v246, s56, v218
  v_fmac_f32 v247, s56, v219
  v_fmac_f32 v248, s56, v220
  v_fmac_f32 v249, s56, v221
  v_fmac_f32 v250, s56, v222
  v_fmac_f32 v251, s56, v223
  v_fmac_f32 v244, s55, v179
  v_fmac_f32 v245, s55, v183
  v_fmac_f32 v246, s55, v187
  v_fmac_f32 v247, s55, v191
  v_fmac_f32 v248, s55, v195
  v_fmac_f32 v249, s55, v199
  v_fmac_f32 v250, s55, v203
  v_fmac_f32 v251, s55, v207
  v_cvt_pk_bf16_f32 v212, v244, v245
  v_cvt_pk_bf16_f32 v213, v246, v247
  v_cvt_pk_bf16_f32 v214, v248, v249
  v_cvt_pk_bf16_f32 v215, v250, v251
  v_mul_f32 v244, s57, v244
  v_mul_f32 v245, s57, v245
  v_mul_f32 v246, s57, v246
  v_mul_f32 v247, s57, v247
  v_mul_f32 v248, s57, v248
  v_mul_f32 v249, s57, v249
  v_mul_f32 v250, s57, v250
  v_mul_f32 v251, s57, v251
  buffer_store_dwordx4 v[212:215], v7, s[40:43], s58 offen sc1
  v_cvt_pk_bf16_f32 v216, v244, v245
  v_cvt_pk_bf16_f32 v217, v246, v247
  v_cvt_pk_bf16_f32 v218, v248, v249
  v_cvt_pk_bf16_f32 v219, v250, v251
  buffer_store_dwordx4 v[216:219], v7, s[40:43], s59 offen sc1
  v_lshrrev_b32 v18, 3, v0
  v_mul_u32_u24 v24, 4224, v18
  v_bfe_u32 v18, v0, 4, 1
  v_lshlrev_b32 v18, 2, v18
  v_and_b32 v19, 7, v0
  v_xor_b32 v18, v18, v19
  v_lshl_add_u32 v24, v18, 4, v24
  v_lshrrev_b32 v18, 5, v0
  v_bfe_u32 v19, v0, 2, 2
  v_lshl_add_u32 v18, v18, 3, v19
  v_lshlrev_b32 v25, 7, v18
  v_lshrrev_b32 v19, 1, v19
  s_lshr_b32 s55, s36, 2
  v_xor_b32 v19, s55, v19
  v_lshl_add_u32 v25, v19, 6, v25
  v_bfe_u32 v19, v0, 4, 1
  v_lshl_add_u32 v25, v19, 5, v25
  v_and_b32 v19, 3, v0
  v_lshl_add_u32 v25, v19, 3, v25
  v_add_u32 v25, 16384, v25
  s_lshl_b32 s56, s92, 6
  s_lshl_b32 s61, s55, 5
  s_add_u32 s56, s56, s61
  v_and_b32 v19, 31, v0
  v_add_u32 v19, s56, v19
  v_lshlrev_b32 v19, 2, v19
  v_add_u32 v28, 90112, v19
  s_lshl_b32 s56, s92, 1
  s_add_u32 s56, s56, s55
  s_mul_i32 s56, s56, 108
  s_lshl_b32 s61, s54, 2
  s_add_u32 s56, s56, s61
  s_and_b32 s61, s36, 3
  s_add_u32 s56, s56, s61
  s_lshl_b32 s56, s56, 10
  s_add_u32 s100, s56, 16777216
  s_mul_i32 s101, s36, 67584
  s_lshl_b32 s55, s92, 7
  s_add_u32 s101, s101, s55
  s_add_u32 s101, s101, 10485760
  v_and_b32 v29, 1, v0
  v_mul_u32_u24 v29, 1280, v29
  v_lshrrev_b32 v19, 5, v0
  v_lshl_add_u32 v29, v19, 4, v29
  v_add_u32 v29, 78336, v29
  v_bfe_u32 v31, v0, 3, 2
  s_and_b32 s55, s36, 3
  v_xor_b32 v31, s55, v31
  v_lshrrev_b32 v30, 4, v0
  v_lshlrev_b32 v30, 10, v30
  v_lshl_add_u32 v30, v31, 5, v30
  v_bfe_u32 v31, v0, 2, 2
  v_lshl_add_u32 v30, v31, 7, v30
  v_and_b32 v31, 3, v0
  v_lshl_add_u32 v30, v31, 3, v30
  v_add_u32 v30, 81920, v30
  v_add_u32 v31, 40960, v30
  s_and_b32 s3, s2, 7
  s_mul_i32 s3, s3, 3072
  s_add_u32 s3, s3, 32768
  v_min_u32 v21, 23, v0
  v_lshlrev_b32 v21, 7, v21
  v_add_u32 v21, s3, v21
  s_branch L_cdone_23
L_cy_22:
  s_setprio 2
  s_barrier
  ds_read_b64_tr_b16 v[64:65], v4 offset:32
  ds_read_b64_tr_b16 v[66:67], v4 offset:0
  ds_read_b64_tr_b16 v[60:61], v3 offset:2688
  ds_read_b64_tr_b16 v[62:63], v3 offset:2784
  ds_read_b64_tr_b16 v[56:57], v3 offset:2304
  ds_read_b64_tr_b16 v[58:59], v3 offset:2400
  ds_read_b64_tr_b16 v[52:53], v3 offset:1920
  ds_read_b64_tr_b16 v[54:55], v3 offset:2016
  ds_read_b64_tr_b16 v[48:49], v3 offset:1536
  ds_read_b64_tr_b16 v[50:51], v3 offset:1632
  ds_read_b64_tr_b16 v[44:45], v3 offset:1152
  ds_read_b64_tr_b16 v[46:47], v3 offset:1248
  ds_read_b64_tr_b16 v[40:41], v3 offset:768
  ds_read_b64_tr_b16 v[42:43], v3 offset:864
  ds_read_b64_tr_b16 v[36:37], v3 offset:384
  ds_read_b64_tr_b16 v[38:39], v3 offset:480
  ds_read_b64_tr_b16 v[32:33], v3 offset:0
  ds_read_b64_tr_b16 v[34:35], v3 offset:96
  ds_read_b64_tr_b16 v[68:69], v4 offset:288
  ds_read_b64_tr_b16 v[70:71], v4 offset:256
  v_subrev_u32 v11, 768, v3
  v_subrev_u32 v3, 3840, v3
  global_load_dword v17, v88, s[34:35] sc1
  global_load_dword v23, v88, s[34:35] offset:1024 sc1
  v_mov_b32 v208, 0
  v_mov_b32 v209, 0
  v_mov_b32 v210, 0
  v_mov_b32 v211, 0
  s_mov_b32 s68, s66
  s_waitcnt lgkmcnt(15)
  v_mfma_f32_16x16x32_bf16 v[204:207], v[60:63], v[64:67], 0
  ds_read_b64_tr_b16 v[72:73], v4 offset:544
  s_waitcnt lgkmcnt(15)
  v_mfma_f32_16x16x32_bf16 v[200:203], v[56:59], v[64:67], 0
  ds_read_b64_tr_b16 v[74:75], v4 offset:512
  s_waitcnt lgkmcnt(14)
  v_mfma_f32_16x16x32_bf16 v[196:199], v[52:55], v[64:67], 0
  ds_read_b64_tr_b16 v[60:61], v11 offset:384
  s_waitcnt lgkmcnt(13)
  v_mfma_f32_16x16x32_bf16 v[192:195], v[48:51], v[64:67], 0
  ds_read_b64_tr_b16 v[62:63], v11 offset:480
  s_waitcnt lgkmcnt(12)
  v_mfma_f32_16x16x32_bf16 v[188:191], v[44:47], v[64:67], 0
  ds_read_b64_tr_b16 v[56:57], v11 offset:0
  s_waitcnt lgkmcnt(11)
  v_mfma_f32_16x16x32_bf16 v[184:187], v[40:43], v[64:67], 0
  ds_read_b64_tr_b16 v[58:59], v11 offset:96
  s_waitcnt lgkmcnt(10)
  v_mfma_f32_16x16x32_bf16 v[180:183], v[36:39], v[64:67], 0
  s_waitcnt lgkmcnt(8)
  v_mfma_f32_16x16x32_bf16 v[176:179], v[32:35], v[64:67], 0
  s_cmp_eq_u32 s68, 0
  s_cbranch_scc1 L_ct_29
L_cl_28:
  s_waitcnt lgkmcnt(6)
  v_mfma_f32_16x16x32_bf16 v[204:207], v[52:55], v[68:71], v[204:207]
  ds_read_b64_tr_b16 v[76:77], v4 offset:800
  v_mfma_f32_16x16x32_bf16 v[200:203], v[48:51], v[68:71], v[200:203]
  ds_read_b64_tr_b16 v[78:79], v4 offset:768
  v_mfma_f32_16x16x32_bf16 v[196:199], v[44:47], v[68:71], v[196:199]
  ds_read_b64_tr_b16 v[52:53], v3 offset:2688
  v_mfma_f32_16x16x32_bf16 v[192:195], v[40:43], v[68:71], v[192:195]
  ds_read_b64_tr_b16 v[54:55], v3 offset:2784
  v_mfma_f32_16x16x32_bf16 v[188:191], v[36:39], v[68:71], v[188:191]
  ds_read_b64_tr_b16 v[48:49], v3 offset:2304
  v_mfma_f32_16x16x32_bf16 v[184:187], v[32:35], v[68:71], v[184:187]
  ds_read_b64_tr_b16 v[50:51], v3 offset:2400
  s_waitcnt lgkmcnt(8)
  v_mfma_f32_16x16x32_bf16 v[180:183], v[60:63], v[68:71], v[180:183]
  s_waitcnt lgkmcnt(6)
  v_mfma_f32_16x16x32_bf16 v[176:179], v[56:59], v[68:71], v[176:179]
  v_mfma_f32_16x16x32_bf16 v[208:211], v[60:63], v[64:67], v[208:211]
  v_mfma_f32_16x16x32_bf16 v[204:207], v[44:47], v[72:75], v[204:207]
  ds_read_b64_tr_b16 v[64:65], v4 offset:1056
  v_mfma_f32_16x16x32_bf16 v[200:203], v[40:43], v[72:75], v[200:203]
  ds_read_b64_tr_b16 v[66:67], v4 offset:1024
  v_mfma_f32_16x16x32_bf16 v[196:199], v[36:39], v[72:75], v[196:199]
  ds_read_b64_tr_b16 v[44:45], v3 offset:1920
  v_mfma_f32_16x16x32_bf16 v[192:195], v[32:35], v[72:75], v[192:195]
  ds_read_b64_tr_b16 v[46:47], v3 offset:2016
  v_mfma_f32_16x16x32_bf16 v[188:191], v[60:63], v[72:75], v[188:191]
  ds_read_b64_tr_b16 v[40:41], v3 offset:1536
  v_mfma_f32_16x16x32_bf16 v[184:187], v[56:59], v[72:75], v[184:187]
  ds_read_b64_tr_b16 v[42:43], v3 offset:1632
  s_waitcnt lgkmcnt(8)
  v_mfma_f32_16x16x32_bf16 v[180:183], v[52:55], v[72:75], v[180:183]
  s_waitcnt lgkmcnt(6)
  v_mfma_f32_16x16x32_bf16 v[176:179], v[48:51], v[72:75], v[176:179]
  global_load_dword v17, v88, s[34:35] sc1
  global_load_dword v23, v88, s[34:35] offset:1024 sc1
  v_mfma_f32_16x16x32_bf16 v[208:211], v[52:55], v[68:71], v[208:211]
  v_mfma_f32_16x16x32_bf16 v[204:207], v[36:39], v[76:79], v[204:207]
  ds_read_b64_tr_b16 v[68:69], v4 offset:1312
  v_mfma_f32_16x16x32_bf16 v[200:203], v[32:35], v[76:79], v[200:203]
  ds_read_b64_tr_b16 v[70:71], v4 offset:1280
  v_mfma_f32_16x16x32_bf16 v[196:199], v[60:63], v[76:79], v[196:199]
  ds_read_b64_tr_b16 v[36:37], v3 offset:1152
  v_mfma_f32_16x16x32_bf16 v[192:195], v[56:59], v[76:79], v[192:195]
  ds_read_b64_tr_b16 v[38:39], v3 offset:1248
  v_mfma_f32_16x16x32_bf16 v[188:191], v[52:55], v[76:79], v[188:191]
  ds_read_b64_tr_b16 v[32:33], v3 offset:768
  v_mfma_f32_16x16x32_bf16 v[184:187], v[48:51], v[76:79], v[184:187]
  ds_read_b64_tr_b16 v[34:35], v3 offset:864
  s_waitcnt lgkmcnt(8)
  v_mfma_f32_16x16x32_bf16 v[180:183], v[44:47], v[76:79], v[180:183]
  s_waitcnt lgkmcnt(6)
  v_mfma_f32_16x16x32_bf16 v[176:179], v[40:43], v[76:79], v[176:179]
  v_mfma_f32_16x16x32_bf16 v[208:211], v[44:47], v[72:75], v[208:211]
  v_mfma_f32_16x16x32_bf16 v[204:207], v[60:63], v[64:67], v[204:207]
  ds_read_b64_tr_b16 v[72:73], v4 offset:1568
  v_mfma_f32_16x16x32_bf16 v[200:203], v[56:59], v[64:67], v[200:203]
  ds_read_b64_tr_b16 v[74:75], v4 offset:1536
  v_mfma_f32_16x16x32_bf16 v[196:199], v[52:55], v[64:67], v[196:199]
  ds_read_b64_tr_b16 v[60:61], v3 offset:384
  v_mfma_f32_16x16x32_bf16 v[192:195], v[48:51], v[64:67], v[192:195]
  ds_read_b64_tr_b16 v[62:63], v3 offset:480
  v_mfma_f32_16x16x32_bf16 v[188:191], v[44:47], v[64:67], v[188:191]
  ds_read_b64_tr_b16 v[56:57], v3 offset:0
  v_mfma_f32_16x16x32_bf16 v[184:187], v[40:43], v[64:67], v[184:187]
  ds_read_b64_tr_b16 v[58:59], v3 offset:96
  s_waitcnt lgkmcnt(8)
  v_mfma_f32_16x16x32_bf16 v[180:183], v[36:39], v[64:67], v[180:183]
  s_waitcnt lgkmcnt(6)
  v_mfma_f32_16x16x32_bf16 v[176:179], v[32:35], v[64:67], v[176:179]
  s_sub_u32 s68, s68, 1
  v_subrev_u32 v3, 3072, v3
  v_add_u32 v4, 1024, v4
  v_mfma_f32_16x16x32_bf16 v[208:211], v[36:39], v[76:79], v[208:211]
  s_cmp_lg_u32 s68, 0
  s_cbranch_scc1 L_cl_28
L_ct_29:
  s_waitcnt lgkmcnt(6)
  v_mfma_f32_16x16x32_bf16 v[204:207], v[52:55], v[68:71], v[204:207]
  ds_read_b64_tr_b16 v[76:77], v4 offset:800
  v_mfma_f32_16x16x32_bf16 v[200:203], v[48:51], v[68:71], v[200:203]
  ds_read_b64_tr_b16 v[78:79], v4 offset:768
  v_mfma_f32_16x16x32_bf16 v[196:199], v[44:47], v[68:71], v[196:199]
  v_mfma_f32_16x16x32_bf16 v[192:195], v[40:43], v[68:71], v[192:195]
  v_mfma_f32_16x16x32_bf16 v[188:191], v[36:39], v[68:71], v[188:191]
  v_mfma_f32_16x16x32_bf16 v[184:187], v[32:35], v[68:71], v[184:187]
  ds_read_b64_tr_b16 v[212:213], v8
  ds_read_b64_tr_b16 v[214:215], v8 offset:1536
  ds_read2st64_b32 v[216:217], v6 offset0:0 offset1:1
  ds_read2st64_b32 v[218:219], v6 offset0:2 offset1:3
  ds_read2st64_b32 v[220:221], v6 offset0:4 offset1:5
  ds_read2st64_b32 v[222:223], v6 offset0:6 offset1:7
  ds_read2st64_b32 v[244:245], v22 offset0:0 offset1:1
  ds_read2st64_b32 v[246:247], v22 offset0:2 offset1:3
  ds_read2st64_b32 v[248:249], v22 offset0:4 offset1:5
  ds_read2st64_b32 v[250:251], v22 offset0:6 offset1:7
  s_waitcnt lgkmcnt(15)
  v_mfma_f32_16x16x32_bf16 v[204:207], v[44:47], v[72:75], v[204:207]
  v_mfma_f32_16x16x32_bf16 v[200:203], v[40:43], v[72:75], v[200:203]
  v_mfma_f32_16x16x32_bf16 v[196:199], v[36:39], v[72:75], v[196:199]
  v_mfma_f32_16x16x32_bf16 v[192:195], v[32:35], v[72:75], v[192:195]
  s_waitcnt lgkmcnt(10)
  v_mfma_f32_16x16x32_bf16 v[204:207], v[36:39], v[76:79], v[204:207]
  s_waitcnt lgkmcnt(9)
  v_lshlrev_b32 v235, 16, v212
  s_waitcnt lgkmcnt(3)
  v_and_b32 v225, 0xffff0000, v244
  v_lshlrev_b32 v244, 16, v244
  v_fmac_f32 v244, v235, v225
  v_and_b32 v236, 0xffff0000, v212
  v_and_b32 v226, 0xffff0000, v245
  v_lshlrev_b32 v245, 16, v245
  v_fmac_f32 v245, v236, v226
  v_lshlrev_b32 v237, 16, v213
  s_waitcnt lgkmcnt(2)
  v_and_b32 v227, 0xffff0000, v246
  v_lshlrev_b32 v246, 16, v246
  v_fmac_f32 v246, v237, v227
  v_and_b32 v238, 0xffff0000, v213
  v_and_b32 v228, 0xffff0000, v247
  v_lshlrev_b32 v247, 16, v247
  v_fmac_f32 v247, v238, v228
  v_mfma_f32_16x16x32_bf16 v[200:203], v[32:35], v[76:79], v[200:203]
  v_lshlrev_b32 v239, 16, v214
  s_waitcnt lgkmcnt(1)
  v_and_b32 v229, 0xffff0000, v248
  v_lshlrev_b32 v248, 16, v248
  v_fmac_f32 v248, v239, v229
  v_and_b32 v240, 0xffff0000, v214
  v_and_b32 v230, 0xffff0000, v249
  v_lshlrev_b32 v249, 16, v249
  v_fmac_f32 v249, v240, v230
  v_lshlrev_b32 v241, 16, v215
  s_waitcnt lgkmcnt(0)
  v_and_b32 v231, 0xffff0000, v250
  v_lshlrev_b32 v250, 16, v250
  v_fmac_f32 v250, v241, v231
  v_and_b32 v242, 0xffff0000, v215
  v_and_b32 v232, 0xffff0000, v251
  v_lshlrev_b32 v251, 16, v251
  v_fmac_f32 v251, v242, v232
  s_mov_b32 s94, s66
  s_mov_b32 s95, s67
  s_lshl_b32 s55, s36, 2
  s_lshr_b32 s65, 0x6a510000, s55
  s_and_b32 s66, s65, 3
  s_bfe_u32 s67, s65, 0x20002
  s_mul_i32 s55, s66, 3072
  s_lshl_b32 s56, s67, 4
  s_add_u32 s55, s55, s56
  v_add_u32 v3, s55, v1
  v_add_u32 v8, s55, v5
  s_mul_i32 s56, s67, 4128
  v_add_u32 v4, s56, v2
  s_lshl_b32 s55, s67, 13
  s_lshl_b32 s56, s66, 11
  s_add_u32 s55, s55, s56
  s_add_u32 s55, s55, 40032
  v_lshl_add_u32 v6, v0, 2, s55
  s_add_u32 s56, s56, 13984
  v_lshl_add_u32 v22, v0, 2, s56
  ds_read_b64_tr_b16 v[64:65], v4 offset:32
  ds_read_b64_tr_b16 v[66:67], v4 offset:0
  ds_read_b64_tr_b16 v[60:61], v3 offset:2688
  ds_read_b64_tr_b16 v[62:63], v3 offset:2784
  ds_read_b64_tr_b16 v[56:57], v3 offset:2304
  ds_read_b64_tr_b16 v[58:59], v3 offset:2400
  ds_read_b64_tr_b16 v[52:53], v3 offset:1920
  ds_read_b64_tr_b16 v[54:55], v3 offset:2016
  ds_read_b64_tr_b16 v[48:49], v3 offset:1536
  ds_read_b64_tr_b16 v[50:51], v3 offset:1632
  ds_read_b64_tr_b16 v[44:45], v3 offset:1152
  ds_read_b64_tr_b16 v[46:47], v3 offset:1248
  ds_read_b64_tr_b16 v[40:41], v3 offset:768
  ds_read_b64_tr_b16 v[42:43], v3 offset:864
  ds_read_b64_tr_b16 v[36:37], v3 offset:384
  ds_read_b64_tr_b16 v[38:39], v3 offset:480
  ds_read_b64_tr_b16 v[32:33], v3 offset:0
  ds_read_b64_tr_b16 v[34:35], v3 offset:96
  ds_read_b64_tr_b16 v[68:69], v4 offset:288
  ds_read_b64_tr_b16 v[70:71], v4 offset:256
  v_subrev_u32 v11, 768, v3
  v_subrev_u32 v3, 3840, v3
  s_add_u32 s58, s52, s95
  s_mul_i32 s58, s58, 4224
  s_lshl_b32 s59, s94, 10
  s_add_u32 s58, s58, s59
  s_add_u32 s59, s58, 10485760
  s_add_u32 s58, s58, 7340032
  v_add_f32_dpp v224, v211, v210 wave_shr:1 row_mask:0xf bank_mask:0xf bound_ctrl:0
  v_add_f32_dpp v225, v211, v178 wave_ror:1 row_mask:0xf bank_mask:0xf
  v_add_f32_dpp v226, v179, v182 wave_ror:1 row_mask:0xf bank_mask:0xf
  v_add_f32_dpp v227, v183, v186 wave_ror:1 row_mask:0xf bank_mask:0xf
  v_add_f32_dpp v228, v187, v190 wave_ror:1 row_mask:0xf bank_mask:0xf
  v_add_f32_dpp v229, v191, v194 wave_ror:1 row_mask:0xf bank_mask:0xf
  v_add_f32_dpp v230, v195, v198 wave_ror:1 row_mask:0xf bank_mask:0xf
  v_add_f32_dpp v231, v199, v202 wave_ror:1 row_mask:0xf bank_mask:0xf
  v_add_f32_dpp v232, v203, v206 wave_ror:1 row_mask:0xf bank_mask:0xf
  v_add_f32_dpp v225, v179, v178 wave_shr:1 row_mask:0xf bank_mask:0xf
  v_add_f32_dpp v226, v183, v182 wave_shr:1 row_mask:0xf bank_mask:0xf
  v_add_f32_dpp v227, v187, v186 wave_shr:1 row_mask:0xf bank_mask:0xf
  v_add_f32_dpp v228, v191, v190 wave_shr:1 row_mask:0xf bank_mask:0xf
  v_add_f32_dpp v229, v195, v194 wave_shr:1 row_mask:0xf bank_mask:0xf
  v_add_f32_dpp v230, v199, v198 wave_shr:1 row_mask:0xf bank_mask:0xf
  v_add_f32_dpp v231, v203, v202 wave_shr:1 row_mask:0xf bank_mask:0xf
  v_add_f32_dpp v232, v207, v206 wave_shr:1 row_mask:0xf bank_mask:0xf
  v_add_f32_dpp v234, v224, v209 wave_shr:1 row_mask:0xf bank_mask:0xf bound_ctrl:0
  v_add_f32_dpp v235, v224, v177 wave_ror:1 row_mask:0xf bank_mask:0xf
  v_add_f32_dpp v236, v225, v181 wave_ror:1 row_mask:0xf bank_mask:0xf
  v_add_f32_dpp v237, v226, v185 wave_ror:1 row_mask:0xf bank_mask:0xf
  v_add_f32_dpp v238, v227, v189 wave_ror:1 row_mask:0xf bank_mask:0xf
  v_add_f32_dpp v239, v228, v193 wave_ror:1 row_mask:0xf bank_mask:0xf
  v_add_f32_dpp v240, v229, v197 wave_ror:1 row_mask:0xf bank_mask:0xf
  v_add_f32_dpp v241, v230, v201 wave_ror:1 row_mask:0xf bank_mask:0xf
  v_add_f32_dpp v242, v231, v205 wave_ror:1 row_mask:0xf bank_mask:0xf
  v_add_f32_dpp v235, v225, v177 wave_shr:1 row_mask:0xf bank_mask:0xf
  v_add_f32_dpp v236, v226, v181 wave_shr:1 row_mask:0xf bank_mask:0xf
  v_add_f32_dpp v237, v227, v185 wave_shr:1 row_mask:0xf bank_mask:0xf
  v_add_f32_dpp v238, v228, v189 wave_shr:1 row_mask:0xf bank_mask:0xf
  v_add_f32_dpp v239, v229, v193 wave_shr:1 row_mask:0xf bank_mask:0xf
  v_add_f32_dpp v240, v230, v197 wave_shr:1 row_mask:0xf bank_mask:0xf
  v_add_f32_dpp v241, v231, v201 wave_shr:1 row_mask:0xf bank_mask:0xf
  v_add_f32_dpp v242, v232, v205 wave_shr:1 row_mask:0xf bank_mask:0xf
  v_add_f32_dpp v179, v234, v176 wave_ror:1 row_mask:0xf bank_mask:0xf
  v_add_f32_dpp v183, v235, v180 wave_ror:1 row_mask:0xf bank_mask:0xf
  v_add_f32_dpp v187, v236, v184 wave_ror:1 row_mask:0xf bank_mask:0xf
  v_add_f32_dpp v191, v237, v188 wave_ror:1 row_mask:0xf bank_mask:0xf
  v_add_f32_dpp v195, v238, v192 wave_ror:1 row_mask:0xf bank_mask:0xf
  v_add_f32_dpp v199, v239, v196 wave_ror:1 row_mask:0xf bank_mask:0xf
  v_add_f32_dpp v203, v240, v200 wave_ror:1 row_mask:0xf bank_mask:0xf
  v_add_f32_dpp v207, v241, v204 wave_ror:1 row_mask:0xf bank_mask:0xf
  v_add_f32_dpp v179, v235, v176 wave_shr:1 row_mask:0xf bank_mask:0xf
  v_add_f32_dpp v183, v236, v180 wave_shr:1 row_mask:0xf bank_mask:0xf
  v_add_f32_dpp v187, v237, v184 wave_shr:1 row_mask:0xf bank_mask:0xf
  v_add_f32_dpp v191, v238, v188 wave_shr:1 row_mask:0xf bank_mask:0xf
  v_add_f32_dpp v195, v239, v192 wave_shr:1 row_mask:0xf bank_mask:0xf
  v_add_f32_dpp v199, v240, v196 wave_shr:1 row_mask:0xf bank_mask:0xf
  v_add_f32_dpp v203, v241, v200 wave_shr:1 row_mask:0xf bank_mask:0xf
  v_add_f32_dpp v207, v242, v204 wave_shr:1 row_mask:0xf bank_mask:0xf
  s_waitcnt vmcnt(0)
  v_min_u32 v16, v17, v23
  v_cmp_eq_u32 vcc, 0, v16
  s_nop 0
  s_cbranch_vccz L_md_31
L_mr_30:
  global_load_dword v17, v88, s[34:35] sc1
  global_load_dword v23, v88, s[34:35] offset:1024 sc1
  s_waitcnt vmcnt(0)
  v_min_u32 v16, v17, v23
  v_cmp_eq_u32 vcc, 0, v16
  s_nop 0
  s_cbranch_vccz L_md_31
  s_sleep 2
  s_add_u32 s79, s79, 1
  s_cmp_lt_u32 s79, 400000
  s_cbranch_scc1 L_mr_30
L_md_31:
  v_add_f32 v17, v17, v23
  s_nop 1
  v_add_f32_dpp v17, v17, v17 quad_perm:[1,0,3,2] row_mask:0xf bank_mask:0xf
  s_nop 1
  v_add_f32_dpp v17, v17, v17 quad_perm:[2,3,0,1] row_mask:0xf bank_mask:0xf
  v_cvt_pk_bf16_f32 v17, v17, v17
  v_lshlrev_b32 v17, 16, v17
  v_add_f32 v16, 1.0, v17
  v_cvt_pk_bf16_f32 v16, v16, v16
  v_lshlrev_b32 v16, 16, v16
  v_readlane_b32 s55, v17, 24
  v_readlane_b32 s72, v16, 36
  s_nop 0
  v_mul_f32 v18, s55, v16
  v_mul_f32 v19, s55, v17
  v_readlane_b32 s70, v18, 12
  v_readlane_b32 s71, v19, 0
  v_readlane_b32 s55, v17, 28
  v_readlane_b32 s75, v16, 40
  s_nop 0
  v_mul_f32 v18, s55, v16
  v_mul_f32 v19, s55, v17
  v_readlane_b32 s73, v18, 16
  v_readlane_b32 s74, v19, 4
  v_readlane_b32 s55, v17, 32
  v_readlane_b32 s78, v16, 44
  s_nop 0
  v_mul_f32 v18, s55, v16
  v_mul_f32 v19, s55, v17
  v_readlane_b32 s76, v18, 20
  v_readlane_b32 s77, v19, 8
  s_cmp_eq_u32 s95, 1
  s_cselect_b32 s55, s73, s70
  s_cselect_b32 s56, s74, s71
  s_cselect_b32 s57, s75, s72
  s_cmp_eq_u32 s95, 2
  s_cselect_b32 s55, s76, s55
  s_cselect_b32 s56, s77, s56
  s_cselect_b32 s57, s78, s57
  v_fmac_f32 v244, s56, v216
  v_fmac_f32 v245, s56, v217
  v_fmac_f32 v246, s56, v218
  v_fmac_f32 v247, s56, v219
  v_fmac_f32 v248, s56, v220
  v_fmac_f32 v249, s56, v221
  v_fmac_f32 v250, s56, v222
  v_fmac_f32 v251, s56, v223
  v_fmac_f32 v244, s55, v179
  v_fmac_f32 v245, s55, v183
  v_fmac_f32 v246, s55, v187
  v_fmac_f32 v247, s55, v191
  v_fmac_f32 v248, s55, v195
  v_fmac_f32 v249, s55, v199
  v_fmac_f32 v250, s55, v203
  v_fmac_f32 v251, s55, v207
  v_cvt_pk_bf16_f32 v212, v244, v245
  v_cvt_pk_bf16_f32 v213, v246, v247
  v_cvt_pk_bf16_f32 v214, v248, v249
  v_cvt_pk_bf16_f32 v215, v250, v251
  v_mul_f32 v244, s57, v244
  v_mul_f32 v245, s57, v245
  v_mul_f32 v246, s57, v246
  v_mul_f32 v247, s57, v247
  v_mul_f32 v248, s57, v248
  v_mul_f32 v249, s57, v249
  v_mul_f32 v250, s57, v250
  v_mul_f32 v251, s57, v251
  buffer_store_dwordx4 v[212:215], v7, s[40:43], s58 offen sc1
  v_cvt_pk_bf16_f32 v216, v244, v245
  v_cvt_pk_bf16_f32 v217, v246, v247
  v_cvt_pk_bf16_f32 v218, v248, v249
  v_cvt_pk_bf16_f32 v219, v250, v251
  buffer_store_dwordx4 v[216:219], v7, s[40:43], s59 offen sc1
  s_setprio 0
L_kp_32:
  v_lshrrev_b32 v18, 3, v0
  v_mul_u32_u24 v24, 4224, v18
  v_bfe_u32 v18, v0, 4, 1
  v_lshlrev_b32 v18, 2, v18
  v_and_b32 v19, 7, v0
  v_xor_b32 v18, v18, v19
  v_lshl_add_u32 v24, v18, 4, v24
  v_lshrrev_b32 v18, 5, v0
  v_bfe_u32 v19, v0, 2, 2
  v_lshl_add_u32 v18, v18, 3, v19
  v_lshlrev_b32 v25, 7, v18
  v_lshrrev_b32 v19, 1, v19
  s_lshr_b32 s55, s36, 2
  v_xor_b32 v19, s55, v19
  v_lshl_add_u32 v25, v19, 6, v25
  v_bfe_u32 v19, v0, 4, 1
  v_lshl_add_u32 v25, v19, 5, v25
  v_and_b32 v19, 3, v0
  v_lshl_add_u32 v25, v19, 3, v25
  v_add_u32 v25, 16384, v25
  s_lshl_b32 s56, s92, 6
  s_lshl_b32 s61, s55, 5
  s_add_u32 s56, s56, s61
  v_and_b32 v19, 31, v0
  v_add_u32 v19, s56, v19
  v_lshlrev_b32 v19, 2, v19
  v_add_u32 v28, 90112, v19
  s_lshl_b32 s56, s92, 1
  s_add_u32 s56, s56, s55
  s_mul_i32 s56, s56, 108
  s_lshl_b32 s61, s54, 2
  s_add_u32 s56, s56, s61
  s_and_b32 s61, s36, 3
  s_add_u32 s56, s56, s61
  s_lshl_b32 s56, s56, 10
  s_add_u32 s100, s56, 16777216
  s_mul_i32 s101, s36, 67584
  s_lshl_b32 s55, s92, 7
  s_add_u32 s101, s101, s55
  s_add_u32 s101, s101, 10485760
  v_and_b32 v29, 1, v0
  v_mul_u32_u24 v29, 1280, v29
  v_lshrrev_b32 v19, 5, v0
  v_lshl_add_u32 v29, v19, 4, v29
  v_add_u32 v29, 78336, v29
  v_bfe_u32 v31, v0, 3, 2
  s_and_b32 s55, s36, 3
  v_xor_b32 v31, s55, v31
  v_lshrrev_b32 v30, 4, v0
  v_lshlrev_b32 v30, 10, v30
  v_lshl_add_u32 v30, v31, 5, v30
  v_bfe_u32 v31, v0, 2, 2
  v_lshl_add_u32 v30, v31, 7, v30
  v_and_b32 v31, 3, v0
  v_lshl_add_u32 v30, v31, 3, v30
  v_add_u32 v30, 81920, v30
  v_add_u32 v31, 40960, v30
  s_and_b32 s3, s2, 7
  s_mul_i32 s3, s3, 3072
  s_add_u32 s3, s3, 32768
  v_min_u32 v21, 23, v0
  v_lshlrev_b32 v21, 7, v21
  v_add_u32 v21, s3, v21
  s_cmp_ge_u32 s94, 1
  s_cbranch_scc1 L_npub_33
  s_sub_u32 s55, s36, 4
  s_min_u32 s55, s55, 2
  s_lshl_b32 s55, s55, 3
  s_add_u32 s55, s55, s53
  s_mul_i32 s56, s94, 512
  s_add_u32 s55, s55, s56
  s_waitcnt vmcnt(0)
  s_lshl_b32 s3, s55, 7
  s_add_u32 s3, s3, 32768
  v_mul_u32_u24 v9, 3072, v0
  v_add_u32 v9, s3, v9
  v_mov_b32 v10, 1
  s_mov_b64 exec, 0xff
  global_atomic_add v9, v10, s[34:35] sc1
  s_mov_b64 exec, -1
L_npub_33:
  v_mov_b32 v208, 0
  v_mov_b32 v209, 0
  v_mov_b32 v210, 0
  v_mov_b32 v211, 0
  s_mov_b32 s68, s66
  s_waitcnt lgkmcnt(15)
  v_mfma_f32_16x16x32_bf16 v[204:207], v[60:63], v[64:67], 0
  ds_read_b64_tr_b16 v[72:73], v4 offset:544
  s_waitcnt lgkmcnt(15)
  v_mfma_f32_16x16x32_bf16 v[200:203], v[56:59], v[64:67], 0
  ds_read_b64_tr_b16 v[74:75], v4 offset:512
  s_waitcnt lgkmcnt(14)
  v_mfma_f32_16x16x32_bf16 v[196:199], v[52:55], v[64:67], 0
  ds_read_b64_tr_b16 v[60:61], v11 offset:384
  s_waitcnt lgkmcnt(13)
  v_mfma_f32_16x16x32_bf16 v[192:195], v[48:51], v[64:67], 0
  ds_read_b64_tr_b16 v[62:63], v11 offset:480
  s_waitcnt lgkmcnt(12)
  v_mfma_f32_16x16x32_bf16 v[188:191], v[44:47], v[64:67], 0
  ds_read_b64_tr_b16 v[56:57], v11 offset:0
  s_waitcnt lgkmcnt(11)
  v_mfma_f32_16x16x32_bf16 v[184:187], v[40:43], v[64:67], 0
  ds_read_b64_tr_b16 v[58:59], v11 offset:96
  s_waitcnt lgkmcnt(10)
  v_mfma_f32_16x16x32_bf16 v[180:183], v[36:39], v[64:67], 0
  s_waitcnt lgkmcnt(8)
  v_mfma_f32_16x16x32_bf16 v[176:179], v[32:35], v[64:67], 0
L_cl_34:
  s_waitcnt lgkmcnt(6)
  v_mfma_f32_16x16x32_bf16 v[204:207], v[52:55], v[68:71], v[204:207]
  ds_read_b64_tr_b16 v[76:77], v4 offset:800
  v_mfma_f32_16x16x32_bf16 v[200:203], v[48:51], v[68:71], v[200:203]
  ds_read_b64_tr_b16 v[78:79], v4 offset:768
  v_mfma_f32_16x16x32_bf16 v[196:199], v[44:47], v[68:71], v[196:199]
  ds_read_b64_tr_b16 v[52:53], v3 offset:2688
  v_mfma_f32_16x16x32_bf16 v[192:195], v[40:43], v[68:71], v[192:195]
  ds_read_b64_tr_b16 v[54:55], v3 offset:2784
  v_mfma_f32_16x16x32_bf16 v[188:191], v[36:39], v[68:71], v[188:191]
  ds_read_b64_tr_b16 v[48:49], v3 offset:2304
  v_mfma_f32_16x16x32_bf16 v[184:187], v[32:35], v[68:71], v[184:187]
  ds_read_b64_tr_b16 v[50:51], v3 offset:2400
  s_waitcnt lgkmcnt(8)
  v_mfma_f32_16x16x32_bf16 v[180:183], v[60:63], v[68:71], v[180:183]
  s_mov_b32 m0, s96
  s_nop 0
  buffer_load_dwordx4 v26, s[44:47], s97 offen lds
  s_waitcnt lgkmcnt(6)
  v_mfma_f32_16x16x32_bf16 v[176:179], v[56:59], v[68:71], v[176:179]
  v_mfma_f32_16x16x32_bf16 v[208:211], v[60:63], v[64:67], v[208:211]
  v_mfma_f32_16x16x32_bf16 v[204:207], v[44:47], v[72:75], v[204:207]
  ds_read_b64_tr_b16 v[64:65], v4 offset:1056
  v_mfma_f32_16x16x32_bf16 v[200:203], v[40:43], v[72:75], v[200:203]
  ds_read_b64_tr_b16 v[66:67], v4 offset:1024
  v_mfma_f32_16x16x32_bf16 v[196:199], v[36:39], v[72:75], v[196:199]
  ds_read_b64_tr_b16 v[44:45], v3 offset:1920
  v_mfma_f32_16x16x32_bf16 v[192:195], v[32:35], v[72:75], v[192:195]
  ds_read_b64_tr_b16 v[46:47], v3 offset:2016
  v_mfma_f32_16x16x32_bf16 v[188:191], v[60:63], v[72:75], v[188:191]
  ds_read_b64_tr_b16 v[40:41], v3 offset:1536
  v_mfma_f32_16x16x32_bf16 v[184:187], v[56:59], v[72:75], v[184:187]
  ds_read_b64_tr_b16 v[42:43], v3 offset:1632
  s_waitcnt lgkmcnt(8)
  v_mfma_f32_16x16x32_bf16 v[180:183], v[52:55], v[72:75], v[180:183]
  s_add_u32 m0, s96, 1024
  s_add_u32 s96, s96, 2048
  buffer_load_dwordx4 v27, s[48:51], s97 offen lds
  s_add_u32 s97, s97, 27648
  s_min_u32 s96, s96, s98
  s_min_u32 s97, s97, s99
  s_waitcnt lgkmcnt(6)
  v_mfma_f32_16x16x32_bf16 v[176:179], v[48:51], v[72:75], v[176:179]
  v_mfma_f32_16x16x32_bf16 v[208:211], v[52:55], v[68:71], v[208:211]
  v_mfma_f32_16x16x32_bf16 v[204:207], v[36:39], v[76:79], v[204:207]
  ds_read_b64_tr_b16 v[68:69], v4 offset:1312
  v_mfma_f32_16x16x32_bf16 v[200:203], v[32:35], v[76:79], v[200:203]
  ds_read_b64_tr_b16 v[70:71], v4 offset:1280
  v_mfma_f32_16x16x32_bf16 v[196:199], v[60:63], v[76:79], v[196:199]
  ds_read_b64_tr_b16 v[36:37], v3 offset:1152
  v_mfma_f32_16x16x32_bf16 v[192:195], v[56:59], v[76:79], v[192:195]
  ds_read_b64_tr_b16 v[38:39], v3 offset:1248
  v_mfma_f32_16x16x32_bf16 v[188:191], v[52:55], v[76:79], v[188:191]
  ds_read_b64_tr_b16 v[32:33], v3 offset:768
  v_mfma_f32_16x16x32_bf16 v[184:187], v[48:51], v[76:79], v[184:187]
  ds_read_b64_tr_b16 v[34:35], v3 offset:864
  s_waitcnt lgkmcnt(8)
  v_mfma_f32_16x16x32_bf16 v[180:183], v[44:47], v[76:79], v[180:183]
  s_mov_b32 m0, s96
  s_nop 0
  buffer_load_dwordx4 v26, s[44:47], s97 offen lds
  s_waitcnt lgkmcnt(6)
  v_mfma_f32_16x16x32_bf16 v[176:179], v[40:43], v[76:79], v[176:179]
  v_mfma_f32_16x16x32_bf16 v[208:211], v[44:47], v[72:75], v[208:211]
  v_mfma_f32_16x16x32_bf16 v[204:207], v[60:63], v[64:67], v[204:207]
  ds_read_b64_tr_b16 v[72:73], v4 offset:1568
  v_mfma_f32_16x16x32_bf16 v[200:203], v[56:59], v[64:67], v[200:203]
  ds_read_b64_tr_b16 v[74:75], v4 offset:1536
  v_mfma_f32_16x16x32_bf16 v[196:199], v[52:55], v[64:67], v[196:199]
  ds_read_b64_tr_b16 v[60:61], v3 offset:384
  v_mfma_f32_16x16x32_bf16 v[192:195], v[48:51], v[64:67], v[192:195]
  ds_read_b64_tr_b16 v[62:63], v3 offset:480
  v_mfma_f32_16x16x32_bf16 v[188:191], v[44:47], v[64:67], v[188:191]
  ds_read_b64_tr_b16 v[56:57], v3 offset:0
  v_mfma_f32_16x16x32_bf16 v[184:187], v[40:43], v[64:67], v[184:187]
  ds_read_b64_tr_b16 v[58:59], v3 offset:96
  s_waitcnt lgkmcnt(8)
  v_mfma_f32_16x16x32_bf16 v[180:183], v[36:39], v[64:67], v[180:183]
  s_add_u32 m0, s96, 1024
  s_add_u32 s96, s96, 2048
  buffer_load_dwordx4 v27, s[48:51], s97 offen lds
  s_add_u32 s97, s97, 27648
  s_min_u32 s96, s96, s98
  s_min_u32 s97, s97, s99
  s_waitcnt lgkmcnt(6)
  v_mfma_f32_16x16x32_bf16 v[176:179], v[32:35], v[64:67], v[176:179]
  s_sub_u32 s68, s68, 1
  v_subrev_u32 v3, 3072, v3
  v_add_u32 v4, 1024, v4
  v_mfma_f32_16x16x32_bf16 v[208:211], v[36:39], v[76:79], v[208:211]
  s_cmp_lg_u32 s68, 0
  s_cbranch_scc1 L_cl_34
L_ct_35:
  global_load_dwordx2 v[12:13], v90, s[34:35] sc1
  global_load_dwordx2 v[14:15], v90, s[34:35] offset:2560 sc1
  v_mfma_f32_16x16x32_bf16 v[204:207], v[52:55], v[68:71], v[204:207]
  ds_read_b64_tr_b16 v[76:77], v4 offset:800
  v_mfma_f32_16x16x32_bf16 v[200:203], v[48:51], v[68:71], v[200:203]
  ds_read_b64_tr_b16 v[78:79], v4 offset:768
  v_mfma_f32_16x16x32_bf16 v[196:199], v[44:47], v[68:71], v[196:199]
  s_mov_b32 m0, s96
  s_nop 0
  buffer_load_dwordx4 v26, s[44:47], s97 offen lds
  v_mfma_f32_16x16x32_bf16 v[192:195], v[40:43], v[68:71], v[192:195]
  v_mfma_f32_16x16x32_bf16 v[188:191], v[36:39], v[68:71], v[188:191]
  s_add_u32 m0, s96, 1024
  s_add_u32 s96, s96, 2048
  buffer_load_dwordx4 v27, s[48:51], s97 offen lds
  s_add_u32 s97, s97, 27648
  s_min_u32 s96, s96, s98
  s_min_u32 s97, s97, s99
  v_mfma_f32_16x16x32_bf16 v[184:187], v[32:35], v[68:71], v[184:187]
  ds_read_b64_tr_b16 v[212:213], v8
  ds_read_b64_tr_b16 v[214:215], v8 offset:1536
  ds_read2st64_b32 v[216:217], v6 offset0:0 offset1:1
  ds_read2st64_b32 v[218:219], v6 offset0:2 offset1:3
  ds_read2st64_b32 v[220:221], v6 offset0:4 offset1:5
  ds_read2st64_b32 v[222:223], v6 offset0:6 offset1:7
  ds_read2st64_b32 v[244:245], v22 offset0:0 offset1:1
  ds_read2st64_b32 v[246:247], v22 offset0:2 offset1:3
  ds_read2st64_b32 v[248:249], v22 offset0:4 offset1:5
  ds_read2st64_b32 v[250:251], v22 offset0:6 offset1:7
  s_waitcnt lgkmcnt(15)
  v_mfma_f32_16x16x32_bf16 v[204:207], v[44:47], v[72:75], v[204:207]
  v_mfma_f32_16x16x32_bf16 v[200:203], v[40:43], v[72:75], v[200:203]
  v_mfma_f32_16x16x32_bf16 v[196:199], v[36:39], v[72:75], v[196:199]
  v_mfma_f32_16x16x32_bf16 v[192:195], v[32:35], v[72:75], v[192:195]
  s_waitcnt lgkmcnt(10)
  v_mfma_f32_16x16x32_bf16 v[204:207], v[36:39], v[76:79], v[204:207]
  s_waitcnt lgkmcnt(9)
  v_lshlrev_b32 v235, 16, v212
  s_waitcnt lgkmcnt(3)
  v_and_b32 v225, 0xffff0000, v244
  v_lshlrev_b32 v244, 16, v244
  v_fmac_f32 v244, v235, v225
  v_and_b32 v236, 0xffff0000, v212
  v_and_b32 v226, 0xffff0000, v245
  v_lshlrev_b32 v245, 16, v245
  v_fmac_f32 v245, v236, v226
  v_lshlrev_b32 v237, 16, v213
  s_waitcnt lgkmcnt(2)
  v_and_b32 v227, 0xffff0000, v246
  v_lshlrev_b32 v246, 16, v246
  v_fmac_f32 v246, v237, v227
  v_and_b32 v238, 0xffff0000, v213
  v_and_b32 v228, 0xffff0000, v247
  v_lshlrev_b32 v247, 16, v247
  v_fmac_f32 v247, v238, v228
  v_mfma_f32_16x16x32_bf16 v[200:203], v[32:35], v[76:79], v[200:203]
  v_lshlrev_b32 v239, 16, v214
  s_waitcnt lgkmcnt(1)
  v_and_b32 v229, 0xffff0000, v248
  v_lshlrev_b32 v248, 16, v248
  v_fmac_f32 v248, v239, v229
  v_and_b32 v240, 0xffff0000, v214
  v_and_b32 v230, 0xffff0000, v249
  v_lshlrev_b32 v249, 16, v249
  v_fmac_f32 v249, v240, v230
  v_lshlrev_b32 v241, 16, v215
  s_waitcnt lgkmcnt(0)
  v_and_b32 v231, 0xffff0000, v250
  v_lshlrev_b32 v250, 16, v250
  v_fmac_f32 v250, v241, v231
  v_and_b32 v242, 0xffff0000, v215
  v_and_b32 v232, 0xffff0000, v251
  v_lshlrev_b32 v251, 16, v251
  v_fmac_f32 v251, v242, v232
  s_add_u32 s58, s52, s67
  s_mul_i32 s58, s58, 4224
  s_lshl_b32 s59, s66, 10
  s_add_u32 s58, s58, s59
  s_add_u32 s59, s58, 10485760
  s_add_u32 s58, s58, 7340032
  v_add_f32_dpp v224, v211, v210 wave_shr:1 row_mask:0xf bank_mask:0xf bound_ctrl:0
  v_add_f32_dpp v225, v211, v178 wave_ror:1 row_mask:0xf bank_mask:0xf
  v_add_f32_dpp v226, v179, v182 wave_ror:1 row_mask:0xf bank_mask:0xf
  v_add_f32_dpp v227, v183, v186 wave_ror:1 row_mask:0xf bank_mask:0xf
  v_add_f32_dpp v228, v187, v190 wave_ror:1 row_mask:0xf bank_mask:0xf
  v_add_f32_dpp v229, v191, v194 wave_ror:1 row_mask:0xf bank_mask:0xf
  v_add_f32_dpp v230, v195, v198 wave_ror:1 row_mask:0xf bank_mask:0xf
  v_add_f32_dpp v231, v199, v202 wave_ror:1 row_mask:0xf bank_mask:0xf
  v_add_f32_dpp v232, v203, v206 wave_ror:1 row_mask:0xf bank_mask:0xf
  v_add_f32_dpp v225, v179, v178 wave_shr:1 row_mask:0xf bank_mask:0xf
  v_add_f32_dpp v226, v183, v182 wave_shr:1 row_mask:0xf bank_mask:0xf
  v_add_f32_dpp v227, v187, v186 wave_shr:1 row_mask:0xf bank_mask:0xf
  v_add_f32_dpp v228, v191, v190 wave_shr:1 row_mask:0xf bank_mask:0xf
  v_add_f32_dpp v229, v195, v194 wave_shr:1 row_mask:0xf bank_mask:0xf
  v_add_f32_dpp v230, v199, v198 wave_shr:1 row_mask:0xf bank_mask:0xf
  v_add_f32_dpp v231, v203, v202 wave_shr:1 row_mask:0xf bank_mask:0xf
  v_add_f32_dpp v232, v207, v206 wave_shr:1 row_mask:0xf bank_mask:0xf
  v_add_f32_dpp v234, v224, v209 wave_shr:1 row_mask:0xf bank_mask:0xf bound_ctrl:0
  v_add_f32_dpp v235, v224, v177 wave_ror:1 row_mask:0xf bank_mask:0xf
  v_add_f32_dpp v236, v225, v181 wave_ror:1 row_mask:0xf bank_mask:0xf
  v_add_f32_dpp v237, v226, v185 wave_ror:1 row_mask:0xf bank_mask:0xf
  v_add_f32_dpp v238, v227, v189 wave_ror:1 row_mask:0xf bank_mask:0xf
  v_add_f32_dpp v239, v228, v193 wave_ror:1 row_mask:0xf bank_mask:0xf
  v_add_f32_dpp v240, v229, v197 wave_ror:1 row_mask:0xf bank_mask:0xf
  v_add_f32_dpp v241, v230, v201 wave_ror:1 row_mask:0xf bank_mask:0xf
  v_add_f32_dpp v242, v231, v205 wave_ror:1 row_mask:0xf bank_mask:0xf
  v_add_f32_dpp v235, v225, v177 wave_shr:1 row_mask:0xf bank_mask:0xf
  v_add_f32_dpp v236, v226, v181 wave_shr:1 row_mask:0xf bank_mask:0xf
  v_add_f32_dpp v237, v227, v185 wave_shr:1 row_mask:0xf bank_mask:0xf
  v_add_f32_dpp v238, v228, v189 wave_shr:1 row_mask:0xf bank_mask:0xf
  v_add_f32_dpp v239, v229, v193 wave_shr:1 row_mask:0xf bank_mask:0xf
  v_add_f32_dpp v240, v230, v197 wave_shr:1 row_mask:0xf bank_mask:0xf
  v_add_f32_dpp v241, v231, v201 wave_shr:1 row_mask:0xf bank_mask:0xf
  v_add_f32_dpp v242, v232, v205 wave_shr:1 row_mask:0xf bank_mask:0xf
  v_add_f32_dpp v179, v234, v176 wave_ror:1 row_mask:0xf bank_mask:0xf
  v_add_f32_dpp v183, v235, v180 wave_ror:1 row_mask:0xf bank_mask:0xf
  v_add_f32_dpp v187, v236, v184 wave_ror:1 row_mask:0xf bank_mask:0xf
  v_add_f32_dpp v191, v237, v188 wave_ror:1 row_mask:0xf bank_mask:0xf
  v_add_f32_dpp v195, v238, v192 wave_ror:1 row_mask:0xf bank_mask:0xf
  v_add_f32_dpp v199, v239, v196 wave_ror:1 row_mask:0xf bank_mask:0xf
  v_add_f32_dpp v203, v240, v200 wave_ror:1 row_mask:0xf bank_mask:0xf
  v_add_f32_dpp v207, v241, v204 wave_ror:1 row_mask:0xf bank_mask:0xf
  v_add_f32_dpp v179, v235, v176 wave_shr:1 row_mask:0xf bank_mask:0xf
  v_add_f32_dpp v183, v236, v180 wave_shr:1 row_mask:0xf bank_mask:0xf
  v_add_f32_dpp v187, v237, v184 wave_shr:1 row_mask:0xf bank_mask:0xf
  v_add_f32_dpp v191, v238, v188 wave_shr:1 row_mask:0xf bank_mask:0xf
  v_add_f32_dpp v195, v239, v192 wave_shr:1 row_mask:0xf bank_mask:0xf
  v_add_f32_dpp v199, v240, v196 wave_shr:1 row_mask:0xf bank_mask:0xf
  v_add_f32_dpp v203, v241, v200 wave_shr:1 row_mask:0xf bank_mask:0xf
  v_add_f32_dpp v207, v242, v204 wave_shr:1 row_mask:0xf bank_mask:0xf
  s_cmp_eq_u32 s67, 1
  s_cselect_b32 s55, s73, s70
  s_cselect_b32 s56, s74, s71
  s_cselect_b32 s57, s75, s72
  s_cmp_eq_u32 s67, 2
  s_cselect_b32 s55, s76, s55
  s_cselect_b32 s56, s77, s56
  s_cselect_b32 s57, s78, s57
  v_fmac_f32 v244, s56, v216
  v_fmac_f32 v245, s56, v217
  v_fmac_f32 v246, s56, v218
  v_fmac_f32 v247, s56, v219
  v_fmac_f32 v248, s56, v220
  v_fmac_f32 v249, s56, v221
  v_fmac_f32 v250, s56, v222
  v_fmac_f32 v251, s56, v223
  v_fmac_f32 v244, s55, v179
  v_fmac_f32 v245, s55, v183
  v_fmac_f32 v246, s55, v187
  v_fmac_f32 v247, s55, v191
  v_fmac_f32 v248, s55, v195
  v_fmac_f32 v249, s55, v199
  v_fmac_f32 v250, s55, v203
  v_fmac_f32 v251, s55, v207
  v_cvt_pk_bf16_f32 v212, v244, v245
  v_cvt_pk_bf16_f32 v213, v246, v247
  v_cvt_pk_bf16_f32 v214, v248, v249
  v_cvt_pk_bf16_f32 v215, v250, v251
  v_mul_f32 v244, s57, v244
  v_mul_f32 v245, s57, v245
  v_mul_f32 v246, s57, v246
  v_mul_f32 v247, s57, v247
  v_mul_f32 v248, s57, v248
  v_mul_f32 v249, s57, v249
  v_mul_f32 v250, s57, v250
  v_mul_f32 v251, s57, v251
  buffer_store_dwordx4 v[212:215], v7, s[40:43], s58 offen sc1
  v_cvt_pk_bf16_f32 v216, v244, v245
  v_cvt_pk_bf16_f32 v217, v246, v247
  v_cvt_pk_bf16_f32 v218, v248, v249
  v_cvt_pk_bf16_f32 v219, v250, v251
  buffer_store_dwordx4 v[216:219], v7, s[40:43], s59 offen sc1
  s_setprio 0
L_cdone_23:
  s_waitcnt vmcnt(5)
  v_min_u32 v16, v12, v13
  s_waitcnt vmcnt(4)
  v_min3_u32 v16, v16, v14, v15
  v_cmp_eq_u32 vcc, 0, v16
  s_nop 0
  s_cbranch_vccz L_tbd_37
L_tb_36:
  global_load_dwordx2 v[12:13], v90, s[34:35] sc1
  global_load_dwordx2 v[14:15], v90, s[34:35] offset:2560 sc1
  s_waitcnt vmcnt(1)
  v_min_u32 v16, v12, v13
  s_waitcnt vmcnt(0)
  v_min3_u32 v16, v16, v14, v15
  v_cmp_eq_u32 vcc, 0, v16
  s_nop 0
  s_cbranch_vccz L_tbd_37
  s_sleep 2
  s_add_u32 s79, s79, 1
  s_cmp_lt_u32 s79, 400000
  s_cbranch_scc1 L_tb_36
L_tbd_37:
  v_and_b32 v14, 0xffff0000, v14
  v_and_b32 v15, 0xffff0000, v15
  v_add_f32 v14, 1.0, v14
  v_add_f32 v15, 1.0, v15
  s_mov_b32 s55, 0x07060302
  v_cvt_pk_bf16_f32 v14, v14, v15
  v_perm_b32 v12, v13, v12, s55
  v_lshlrev_b32 v20, 2, v89
  v_add_u32 v20, 78336, v20
  ds_write_b32 v20, v14
  ds_write_b32 v20, v12 offset:1280
  v_mov_b32 v1, v24
  v_mov_b32 v2, v25
  v_add_u32 v3, 49152, v25
  v_mov_b32 v6, v28
  v_mov_b32 v8, v29
  v_mov_b32 v10, v30
  v_mov_b32 v11, v31
  v_mov_b32 v7, v21
  s_mov_b32 s65, s100
  s_mov_b32 s66, s101
  s_lshl_b32 s67, s36, 11
  s_cmp_lg_u32 s36, 0
  s_cbranch_scc1 L_ow_38
  v_mov_b32 v5, 0
  s_mov_b64 exec, 0xffffff
  global_atomic_add v5, v7, v5, s[34:35] offset:0 sc0 sc1
  s_mov_b64 exec, -1
  s_waitcnt vmcnt(0)
  v_cmp_gt_u32 vcc, 27, v5
  s_nop 0
  s_and_b32 vcc_lo, vcc_lo, 0xffffff
  s_cbranch_scc0 L_polld_40
L_poll_39:
  s_sleep 2
  v_mov_b32 v5, 0
  s_mov_b64 exec, 0xffffff
  global_atomic_add v5, v7, v5, s[34:35] offset:0 sc0 sc1
  s_mov_b64 exec, -1
  s_waitcnt vmcnt(0)
  v_cmp_gt_u32 vcc, 27, v5
  s_nop 0
  s_and_b32 vcc_lo, vcc_lo, 0xffffff
  s_cbranch_scc0 L_polld_40
  s_add_u32 s79, s79, 1
  s_cmp_lt_u32 s79, 400000
  s_cbranch_scc1 L_poll_39
L_polld_40:
L_ow_38:
  s_waitcnt vmcnt(2) lgkmcnt(0)
  s_barrier
  s_add_u32 m0, s67, 16384
  s_add_u32 s3, s66, 0
  buffer_load_dwordx4 v1, s[40:43], s3 offen sc1 lds
  s_add_u32 m0, s67, 17408
  s_add_u32 s3, s66, 33792
  buffer_load_dwordx4 v1, s[40:43], s3 offen sc1 lds
  s_add_u32 m0, s67, 32768
  s_add_u32 s3, s66, 540672
  buffer_load_dwordx4 v1, s[40:43], s3 offen sc1 lds
  s_add_u32 m0, s67, 33792
  s_add_u32 s3, s66, 574464
  buffer_load_dwordx4 v1, s[40:43], s3 offen sc1 lds
  ds_read_b64_tr_b16 v[176:177], v10 offset:0
  ds_read_b64_tr_b16 v[178:179], v10 offset:512
  ds_read_b64_tr_b16 v[180:181], v10 offset:4096
  ds_read_b64_tr_b16 v[182:183], v10 offset:4608
  ds_read_b64_tr_b16 v[184:185], v10 offset:8192
  ds_read_b64_tr_b16 v[186:187], v10 offset:8704
  ds_read_b64_tr_b16 v[188:189], v10 offset:12288
  ds_read_b64_tr_b16 v[190:191], v10 offset:12800
  ds_read_b64_tr_b16 v[192:193], v10 offset:16384
  ds_read_b64_tr_b16 v[194:195], v10 offset:16896
  ds_read_b64_tr_b16 v[196:197], v10 offset:20480
  ds_read_b64_tr_b16 v[198:199], v10 offset:20992
  ds_read_b64_tr_b16 v[200:201], v10 offset:24576
  ds_read_b64_tr_b16 v[202:203], v10 offset:25088
  ds_read_b64_tr_b16 v[204:205], v10 offset:28672
  ds_read_b64_tr_b16 v[206:207], v10 offset:29184
  ds_read_b64_tr_b16 v[208:209], v10 offset:32768
  ds_read_b64_tr_b16 v[210:211], v10 offset:33280
  ds_read_b64_tr_b16 v[212:213], v10 offset:36864
  ds_read_b64_tr_b16 v[214:215], v10 offset:37376
  ds_read_b64_tr_b16 v[216:217], v11 offset:0
  ds_read_b64_tr_b16 v[218:219], v11 offset:512
  ds_read_b64_tr_b16 v[220:221], v11 offset:4096
  ds_read_b64_tr_b16 v[222:223], v11 offset:4608
  ds_read_b64_tr_b16 v[224:225], v11 offset:8192
  ds_read_b64_tr_b16 v[226:227], v11 offset:8704
  ds_read_b64_tr_b16 v[228:229], v11 offset:12288
  ds_read_b64_tr_b16 v[230:231], v11 offset:12800
  ds_read_b64_tr_b16 v[232:233], v11 offset:16384
  ds_read_b64_tr_b16 v[234:235], v11 offset:16896
  ds_read_b64_tr_b16 v[236:237], v11 offset:20480
  ds_read_b64_tr_b16 v[238:239], v11 offset:20992
  ds_read_b64_tr_b16 v[240:241], v11 offset:24576
  ds_read_b64_tr_b16 v[242:243], v11 offset:25088
  ds_read_b64_tr_b16 v[244:245], v11 offset:28672
  ds_read_b64_tr_b16 v[246:247], v11 offset:29184
  ds_read_b64_tr_b16 v[248:249], v11 offset:32768
  ds_read_b64_tr_b16 v[250:251], v11 offset:33280
  ds_read_b64_tr_b16 v[252:253], v11 offset:36864
  ds_read_b64_tr_b16 v[254:255], v11 offset:37376
  s_add_u32 m0, s67, 49152
  s_add_u32 s3, s66, 1081344
  buffer_load_dwordx4 v1, s[40:43], s3 offen sc1 lds
  s_add_u32 m0, s67, 50176
  s_add_u32 s3, s66, 1115136
  buffer_load_dwordx4 v1, s[40:43], s3 offen sc1 lds
  s_cmp_ge_u32 s36, 4
  s_cbranch_scc1 L_csj_41
  s_mul_i32 s55, s92, 160
  v_add_u32 v8, s55, v8
  ds_read_b128 v[48:51], v8 offset:0
  ds_read_b128 v[52:55], v8 offset:32
  ds_read_b128 v[56:59], v8 offset:64
  ds_read_b128 v[60:63], v8 offset:96
  ds_read_b128 v[64:67], v8 offset:128
  s_cmp_eq_u32 s92, 1
  s_cbranch_scc1 L_csv_43
  s_cmp_eq_u32 s92, 2
  s_cbranch_scc1 L_csv_44
  s_cmp_eq_u32 s92, 3
  s_cbranch_scc1 L_csv_45
  s_cmp_eq_u32 s92, 4
  s_cbranch_scc1 L_csv_46
  s_cmp_eq_u32 s92, 5
  s_cbranch_scc1 L_csv_47
  s_cmp_eq_u32 s92, 6
  s_cbranch_scc1 L_csv_48
  s_cmp_eq_u32 s92, 7
  s_cbranch_scc1 L_csv_49
L_csv_42:
  s_waitcnt lgkmcnt(4)
  v_mfma_f32_32x32x16_bf16 v[32:47], v[48:51], v[96:99], 0
  s_waitcnt lgkmcnt(3)
  v_mfma_f32_32x32x16_bf16 v[32:47], v[52:55], v[100:103], v[32:47]
  s_waitcnt lgkmcnt(2)
  v_mfma_f32_32x32x16_bf16 v[32:47], v[56:59], v[104:107], v[32:47]
  s_waitcnt lgkmcnt(1)
  v_mfma_f32_32x32x16_bf16 v[32:47], v[60:63], v[108:111], v[32:47]
  s_waitcnt lgkmcnt(0)
  v_mfma_f32_32x32x16_bf16 v[32:47], v[64:67], v[112:115], v[32:47]
  s_branch L_cse_50
L_csv_43:
  s_waitcnt lgkmcnt(4)
  v_mfma_f32_32x32x16_bf16 v[32:47], v[48:51], v[116:119], 0
  s_waitcnt lgkmcnt(3)
  v_mfma_f32_32x32x16_bf16 v[32:47], v[52:55], v[120:123], v[32:47]
  s_waitcnt lgkmcnt(2)
  v_mfma_f32_32x32x16_bf16 v[32:47], v[56:59], v[124:127], v[32:47]
  s_waitcnt lgkmcnt(1)
  v_mfma_f32_32x32x16_bf16 v[32:47], v[60:63], v[128:131], v[32:47]
  s_waitcnt lgkmcnt(0)
  v_mfma_f32_32x32x16_bf16 v[32:47], v[64:67], v[132:135], v[32:47]
  s_branch L_cse_50
L_csv_44:
  s_waitcnt lgkmcnt(4)
  v_mfma_f32_32x32x16_bf16 v[32:47], v[48:51], v[136:139], 0
  s_waitcnt lgkmcnt(3)
  v_mfma_f32_32x32x16_bf16 v[32:47], v[52:55], v[140:143], v[32:47]
  s_waitcnt lgkmcnt(2)
  v_mfma_f32_32x32x16_bf16 v[32:47], v[56:59], v[144:147], v[32:47]
  s_waitcnt lgkmcnt(1)
  v_mfma_f32_32x32x16_bf16 v[32:47], v[60:63], v[148:151], v[32:47]
  s_waitcnt lgkmcnt(0)
  v_mfma_f32_32x32x16_bf16 v[32:47], v[64:67], v[152:155], v[32:47]
  s_branch L_cse_50
L_csv_45:
  s_waitcnt lgkmcnt(4)
  v_mfma_f32_32x32x16_bf16 v[32:47], v[48:51], v[156:159], 0
  s_waitcnt lgkmcnt(3)
  v_mfma_f32_32x32x16_bf16 v[32:47], v[52:55], v[160:163], v[32:47]
  s_waitcnt lgkmcnt(2)
  v_mfma_f32_32x32x16_bf16 v[32:47], v[56:59], v[164:167], v[32:47]
  s_waitcnt lgkmcnt(1)
  v_mfma_f32_32x32x16_bf16 v[32:47], v[60:63], v[168:171], v[32:47]
  s_waitcnt lgkmcnt(0)
  v_mfma_f32_32x32x16_bf16 v[32:47], v[64:67], v[172:175], v[32:47]
  s_branch L_cse_50
L_csv_46:
  s_waitcnt lgkmcnt(4)
  v_mfma_f32_32x32x16_bf16 v[32:47], v[48:51], v[176:179], 0
  s_waitcnt lgkmcnt(3)
  v_mfma_f32_32x32x16_bf16 v[32:47], v[52:55], v[180:183], v[32:47]
  s_waitcnt lgkmcnt(2)
  v_mfma_f32_32x32x16_bf16 v[32:47], v[56:59], v[184:187], v[32:47]
  s_waitcnt lgkmcnt(1)
  v_mfma_f32_32x32x16_bf16 v[32:47], v[60:63], v[188:191], v[32:47]
  s_waitcnt lgkmcnt(0)
  v_mfma_f32_32x32x16_bf16 v[32:47], v[64:67], v[192:195], v[32:47]
  s_branch L_cse_50
L_csv_47:
  s_waitcnt lgkmcnt(4)
  v_mfma_f32_32x32x16_bf16 v[32:47], v[48:51], v[196:199], 0
  s_waitcnt lgkmcnt(3)
  v_mfma_f32_32x32x16_bf16 v[32:47], v[52:55], v[200:203], v[32:47]
  s_waitcnt lgkmcnt(2)
  v_mfma_f32_32x32x16_bf16 v[32:47], v[56:59], v[204:207], v[32:47]
  s_waitcnt lgkmcnt(1)
  v_mfma_f32_32x32x16_bf16 v[32:47], v[60:63], v[208:211], v[32:47]
  s_waitcnt lgkmcnt(0)
  v_mfma_f32_32x32x16_bf16 v[32:47], v[64:67], v[212:215], v[32:47]
  s_branch L_cse_50
L_csv_48:
  s_waitcnt lgkmcnt(4)
  v_mfma_f32_32x32x16_bf16 v[32:47], v[48:51], v[216:219], 0
  s_waitcnt lgkmcnt(3)
  v_mfma_f32_32x32x16_bf16 v[32:47], v[52:55], v[220:223], v[32:47]
  s_waitcnt lgkmcnt(2)
  v_mfma_f32_32x32x16_bf16 v[32:47], v[56:59], v[224:227], v[32:47]
  s_waitcnt lgkmcnt(1)
  v_mfma_f32_32x32x16_bf16 v[32:47], v[60:63], v[228:231], v[32:47]
  s_waitcnt lgkmcnt(0)
  v_mfma_f32_32x32x16_bf16 v[32:47], v[64:67], v[232:235], v[32:47]
  s_branch L_cse_50
L_csv_49:
  s_waitcnt lgkmcnt(4)
  v_mfma_f32_32x32x16_bf16 v[32:47], v[48:51], v[236:239], 0
  s_waitcnt lgkmcnt(3)
  v_mfma_f32_32x32x16_bf16 v[32:47], v[52:55], v[240:243], v[32:47]
  s_waitcnt lgkmcnt(2)
  v_mfma_f32_32x32x16_bf16 v[32:47], v[56:59], v[244:247], v[32:47]
  s_waitcnt lgkmcnt(1)
  v_mfma_f32_32x32x16_bf16 v[32:47], v[60:63], v[248:251], v[32:47]
  s_waitcnt lgkmcnt(0)
  v_mfma_f32_32x32x16_bf16 v[32:47], v[64:67], v[252:255], v[32:47]
L_cse_50:
  s_lshl_b32 s55, s54, 3
  s_add_u32 s55, s55, s92
  s_lshl_b32 s55, s55, 2
  s_add_u32 s55, s55, s36
  s_lshl_b32 s55, s55, 8
  s_add_u32 s55, s55, 3932160
  v_lshlrev_b32 v9, 3, v0
  s_nop 4
  v_or_b32 v32, 1, v32
  v_or_b32 v33, 1, v33
  s_mov_b32 exec_hi, 0
  buffer_store_dwordx2 v[32:33], v9, s[40:43], s55 offen sc1
  s_mov_b32 exec_hi, -1
L_csj_41:
  s_waitcnt vmcnt(4) lgkmcnt(0)
  s_barrier
  s_cmp_lg_u32 s36, 4
  s_cbranch_scc1 L_ow_51
  s_mul_i32 s55, s91, 0x5556
  s_lshr_b32 s55, s55, 16
  s_mul_i32 s55, s55, 3
  s_sub_u32 s55, s91, s55
  s_lshl_b32 s55, s55, 3
  s_add_u32 s55, s55, s53
  s_lshl_b32 s3, s55, 7
  s_add_u32 s3, s3, 57344
  v_mul_u32_u24 v12, 3072, v0
  v_add_u32 v12, s3, v12
  v_mov_b32 v13, 1
  s_mov_b64 exec, 0xff
  global_atomic_add v12, v13, s[34:35] sc1
  s_mov_b64 exec, -1
L_ow_51:
  v_mov_b32 v14, 0
  v_mov_b32 v15, 0
  ds_read_b64_tr_b16 v[16:17], v2 offset:0
  ds_read_b64_tr_b16 v[18:19], v2 offset:512
  ds_read_b64_tr_b16 v[20:21], v2 offset:2048
  ds_read_b64_tr_b16 v[22:23], v2 offset:2560
  ds_read_b64_tr_b16 v[24:25], v2 offset:4096
  ds_read_b64_tr_b16 v[26:27], v2 offset:4608
  ds_read_b64_tr_b16 v[28:29], v2 offset:6144
  ds_read_b64_tr_b16 v[30:31], v2 offset:6656
  s_waitcnt lgkmcnt(6)
  v_mfma_f32_32x32x16_bf16 v[32:47], v[96:99], v[16:19], 0
  s_add_u32 m0, s67, 65536
  s_add_u32 s3, s66, 1622016
  buffer_load_dwordx4 v1, s[40:43], s3 offen sc1 lds
  ds_read_b64_tr_b16 v[16:17], v2 offset:8192
  ds_read_b64_tr_b16 v[18:19], v2 offset:8704
  s_waitcnt lgkmcnt(6)
  v_mfma_f32_32x32x16_bf16 v[32:47], v[100:103], v[20:23], v[32:47]
  s_add_u32 m0, s67, 66560
  s_add_u32 s3, s66, 1655808
  buffer_load_dwordx4 v1, s[40:43], s3 offen sc1 lds
  ds_read_b64_tr_b16 v[20:21], v2 offset:10240
  ds_read_b64_tr_b16 v[22:23], v2 offset:10752
  s_waitcnt lgkmcnt(6)
  v_mfma_f32_32x32x16_bf16 v[32:47], v[104:107], v[24:27], v[32:47]
  s_add_u32 m0, s67, 81920
  s_add_u32 s3, s66, 2162688
  buffer_load_dwordx4 v1, s[40:43], s3 offen sc1 lds
  ds_read_b64_tr_b16 v[24:25], v2 offset:12288
  ds_read_b64_tr_b16 v[26:27], v2 offset:12800
  s_waitcnt lgkmcnt(6)
  v_mfma_f32_32x32x16_bf16 v[32:47], v[108:111], v[28:31], v[32:47]
  s_waitcnt vmcnt(5)
  s_barrier
  ds_read_b64_tr_b16 v[28:29], v2 offset:14336
  ds_read_b64_tr_b16 v[30:31], v2 offset:14848
  s_waitcnt lgkmcnt(6)
  v_mfma_f32_32x32x16_bf16 v[32:47], v[112:115], v[16:19], v[32:47]
  s_add_u32 m0, s67, 82944
  s_add_u32 s3, s66, 2196480
  buffer_load_dwordx4 v1, s[40:43], s3 offen sc1 lds
  ds_read_b64_tr_b16 v[16:17], v2 offset:16384
  ds_read_b64_tr_b16 v[18:19], v2 offset:16896
  s_lshl_b32 s55, s54, 13
  s_and_b32 s56, s36, 3
  s_lshl_b32 s56, s56, 8
  s_add_u32 s55, s55, s56
  s_waitcnt lgkmcnt(6)
  v_mfma_f32_32x32x16_bf16 v[32:47], v[116:119], v[20:23], v[32:47]
  ds_read_b64_tr_b16 v[20:21], v2 offset:18432
  ds_read_b64_tr_b16 v[22:23], v2 offset:18944
  s_add_u32 s55, s55, 3932160
  v_lshrrev_b32 v79, 5, v0
  v_lshlrev_b32 v79, 12, v79
  v_and_b32 v78, 31, v0
  s_waitcnt lgkmcnt(6)
  v_mfma_f32_32x32x16_bf16 v[32:47], v[120:123], v[24:27], v[32:47]
  ds_read_b64_tr_b16 v[24:25], v2 offset:20480
  ds_read_b64_tr_b16 v[26:27], v2 offset:20992
  v_lshl_add_u32 v79, v78, 3, v79
  v_add_u32 v79, s55, v79
  s_lshr_b32 s55, s2, 3
  s_and_b32 s61, s55, 7
  s_waitcnt lgkmcnt(6)
  v_mfma_f32_32x32x16_bf16 v[32:47], v[124:127], v[28:31], v[32:47]
  ds_read_b64_tr_b16 v[28:29], v2 offset:22528
  ds_read_b64_tr_b16 v[30:31], v2 offset:23040
  s_lshr_b32 s55, s55, 3
  s_and_b32 s90, s55, 1
  s_lshr_b32 s55, s55, 1
  s_lshl_b32 s55, s55, 3
  s_waitcnt lgkmcnt(6)
  v_mfma_f32_32x32x16_bf16 v[32:47], v[128:131], v[16:19], v[32:47]
  ds_read_b64_tr_b16 v[16:17], v2 offset:24576
  ds_read_b64_tr_b16 v[18:19], v2 offset:25088
  s_add_u32 s62, s55, s53
  s_mul_i32 s55, s36, 5120
  s_add_u32 s64, s55, 122880
  s_add_u32 s60, s55, 98304
  s_waitcnt lgkmcnt(6)
  v_mfma_f32_32x32x16_bf16 v[32:47], v[132:135], v[20:23], v[32:47]
  s_cmp_lg_u32 s36, 0
  s_cbranch_scc1 L_ow_52
  s_and_b32 s3, s2, 7
  s_mul_i32 s3, s3, 3072
  s_add_u32 s3, s3, 57344
  v_min_u32 v7, 23, v0
  v_lshlrev_b32 v7, 7, v7
  v_add_u32 v7, s3, v7
  v_mov_b32 v8, 0
  s_mov_b64 exec, 0xffffff
  global_atomic_add v8, v7, v8, s[34:35] offset:0 sc0 sc1
  s_mov_b64 exec, -1
L_ow_52:
  ds_read_b64_tr_b16 v[20:21], v2 offset:26624
  ds_read_b64_tr_b16 v[22:23], v2 offset:27136
  s_sub_u32 s56, s55, 20480
  s_cmp_ge_u32 s36, 4
  s_cselect_b32 s60, s56, s60
  s_add_u32 s78, s60, 4096
  s_waitcnt lgkmcnt(6)
  v_mfma_f32_32x32x16_bf16 v[32:47], v[136:139], v[24:27], v[32:47]
  ds_read_b64_tr_b16 v[24:25], v2 offset:28672
  ds_read_b64_tr_b16 v[26:27], v2 offset:29184
  s_cmp_eq_u32 s36, 7
  s_cmov_b32 s60, 118784
  s_cmov_b32 s78, 15360
  s_mul_i32 s63, s61, 276480
  s_waitcnt lgkmcnt(6)
  v_mfma_f32_32x32x16_bf16 v[32:47], v[140:143], v[28:31], v[32:47]
  s_waitcnt vmcnt(4)
  s_barrier
  ds_read_b64_tr_b16 v[28:29], v2 offset:30720
  ds_read_b64_tr_b16 v[30:31], v2 offset:31232
  s_waitcnt lgkmcnt(6)
  v_mfma_f32_32x32x16_bf16 v[32:47], v[144:147], v[16:19], v[32:47]
  ds_read_b64_tr_b16 v[16:17], v2 offset:32768
  ds_read_b64_tr_b16 v[18:19], v2 offset:33280
  s_add_u32 s63, s63, 13631488
  s_add_u32 s63, s63, s55
  v_lshlrev_b32 v4, 4, v0
  v_lshrrev_b32 v76, 5, v0
  s_waitcnt lgkmcnt(6)
  v_mfma_f32_32x32x16_bf16 v[32:47], v[148:151], v[20:23], v[32:47]
  ds_read_b64_tr_b16 v[20:21], v2 offset:34816
  ds_read_b64_tr_b16 v[22:23], v2 offset:35328
  v_lshlrev_b32 v64, 10, v76
  v_bfe_u32 v76, v0, 4, 1
  v_lshl_add_u32 v64, v76, 9, v64
  v_and_b32 v77, 15, v0
  s_waitcnt lgkmcnt(6)
  v_mfma_f32_32x32x16_bf16 v[32:47], v[152:155], v[24:27], v[32:47]
  ds_read_b64_tr_b16 v[24:25], v2 offset:36864
  ds_read_b64_tr_b16 v[26:27], v2 offset:37376
  v_lshl_add_u32 v64, v77, 4, v64
  s_lshl_b32 s55, s62, 1
  s_add_u32 s55, s55, s90
  s_mul_i32 s55, s55, 110592
  s_waitcnt lgkmcnt(6)
  v_mfma_f32_32x32x16_bf16 v[32:47], v[156:159], v[28:31], v[32:47]
  ds_read_b64_tr_b16 v[28:29], v2 offset:38912
  ds_read_b64_tr_b16 v[30:31], v2 offset:39424
  s_lshl_b32 s56, s36, 11
  s_add_u32 s55, s55, s56
  s_add_u32 s83, s55, 16777216
  s_add_u32 s76, s63, 245760
  s_waitcnt lgkmcnt(6)
  v_mfma_f32_32x32x16_bf16 v[32:47], v[160:163], v[16:19], v[32:47]
  ds_read_b64_tr_b16 v[16:17], v2 offset:40960
  ds_read_b64_tr_b16 v[18:19], v2 offset:41472
  s_add_u32 s77, s83, 98304
  s_cmp_ge_u32 s36, 6
  s_cmov_b32 s76, 0x2000000
  s_cmov_b32 s77, 0x2000000
  s_lshl_b32 s55, s62, 7
  s_waitcnt lgkmcnt(6)
  v_mfma_f32_32x32x16_bf16 v[32:47], v[164:167], v[20:23], v[32:47]
  ds_read_b64_tr_b16 v[20:21], v2 offset:43008
  ds_read_b64_tr_b16 v[22:23], v2 offset:43520
  s_add_u32 s55, s55, 86016
  v_mov_b32 v65, s55
  s_lshl_b32 s55, s36, 10
  s_add_u32 s55, s55, 0
  s_waitcnt lgkmcnt(6)
  v_mfma_f32_32x32x16_bf16 v[32:47], v[168:171], v[24:27], v[32:47]
  ds_read_b64_tr_b16 v[24:25], v2 offset:45056
  ds_read_b64_tr_b16 v[26:27], v2 offset:45568
  v_add_u32 v66, s55, v4
  v_add_u32 v67, 65536, v66
  s_lshl_b32 s55, s36, 13
  s_add_u32 s55, s55, 0
  s_waitcnt lgkmcnt(6)
  v_mfma_f32_32x32x16_bf16 v[32:47], v[172:175], v[28:31], v[32:47]
  s_cmp_lg_u32 s36, 0
  s_cbranch_scc1 L_ow_53
  s_waitcnt vmcnt(0)
  v_cmp_gt_u32 vcc, 9, v8
  s_nop 0
  s_and_b32 vcc_lo, vcc_lo, 0xffffff
  s_cbranch_scc0 L_polld_55
L_poll_54:
  s_sleep 2
  v_mov_b32 v8, 0
  s_mov_b64 exec, 0xffffff
  global_atomic_add v8, v7, v8, s[34:35] offset:0 sc0 sc1
  s_mov_b64 exec, -1
  s_waitcnt vmcnt(0)
  v_cmp_gt_u32 vcc, 9, v8
  s_nop 0
  s_and_b32 vcc_lo, vcc_lo, 0xffffff
  s_cbranch_scc0 L_polld_55
  s_add_u32 s79, s79, 1
  s_cmp_lt_u32 s79, 400000
  s_cbranch_scc1 L_poll_54
L_polld_55:
L_ow_53:
  s_waitcnt vmcnt(2)
  s_barrier
  ds_read_b64_tr_b16 v[28:29], v2 offset:47104
  ds_read_b64_tr_b16 v[30:31], v2 offset:47616
  s_waitcnt lgkmcnt(6)
  v_mfma_f32_32x32x16_bf16 v[32:47], v[176:179], v[16:19], v[32:47]
  s_cmp_lg_u32 s36, 0
  s_cbranch_scc1 L_ow_56
  s_and_b32 s3, s2, 7
  s_mul_i32 s3, s3, 512
  s_add_u32 s3, s3, 81920
  v_min_u32 v7, 3, v0
  v_lshlrev_b32 v7, 7, v7
  v_add_u32 v7, s3, v7
  s_waitcnt vmcnt(0)
  v_mov_b32 v8, 0
  s_mov_b64 exec, 0xf
  global_atomic_add v8, v7, v8, s[34:35] offset:0 sc0 sc1
  s_mov_b64 exec, -1
L_ow_56:
  s_add_u32 m0, s67, 16384
  s_add_u32 s3, s66, 1024
  buffer_load_dwordx4 v1, s[40:43], s3 offen sc1 lds
  ds_read_b64_tr_b16 v[16:17], v3 offset:0
  ds_read_b64_tr_b16 v[18:19], v3 offset:512
  v_add_u32 v68, s55, v4
  s_lshr_b32 s57, s36, 2
  s_and_b32 s58, s36, 3
  s_lshl_b32 s55, s57, 13
  s_waitcnt lgkmcnt(6)
  v_mfma_f32_32x32x16_bf16 v[32:47], v[180:183], v[20:23], v[32:47]
  s_add_u32 m0, s67, 17408
  s_add_u32 s3, s66, 34816
  buffer_load_dwordx4 v1, s[40:43], s3 offen sc1 lds
  ds_read_b64_tr_b16 v[20:21], v3 offset:2048
  ds_read_b64_tr_b16 v[22:23], v3 offset:2560
  s_lshl_b32 s56, s58, 8
  s_add_u32 s55, s55, s56
  s_add_u32 s55, s55, 65536
  v_lshl_add_u32 v69, v77, 4, s55
  s_waitcnt lgkmcnt(6)
  v_mfma_f32_32x32x16_bf16 v[32:47], v[184:187], v[24:27], v[32:47]
  s_add_u32 m0, s67, 32768
  s_add_u32 s3, s66, 541696
  buffer_load_dwordx4 v1, s[40:43], s3 offen sc1 lds
  ds_read_b64_tr_b16 v[24:25], v3 offset:4096
  ds_read_b64_tr_b16 v[26:27], v3 offset:4608
  s_cmp_ge_u32 s36, 5
  s_cselect_b32 s59, 1, 0
  s_mul_i32 s55, s59, 5
  s_sub_u32 s86, s36, s55
  s_add_u32 s57, s57, 3
  s_waitcnt lgkmcnt(6)
  v_mfma_f32_32x32x16_bf16 v[32:47], v[188:191], v[28:31], v[32:47]
  s_add_u32 m0, s67, 33792
  s_add_u32 s3, s66, 575488
  buffer_load_dwordx4 v1, s[40:43], s3 offen sc1 lds
  ds_read_b64_tr_b16 v[28:29], v3 offset:6144
  ds_read_b64_tr_b16 v[30:31], v3 offset:6656
  v_lshrrev_b32 v76, 2, v0
  v_lshlrev_b32 v70, 6, v76
  v_and_b32 v78, 3, v0
  v_lshl_add_u32 v70, v78, 3, v70
  s_waitcnt lgkmcnt(6)
  v_mfma_f32_32x32x16_bf16 v[32:47], v[192:195], v[16:19], v[32:47]
  ds_read_b64_tr_b16 v[16:17], v3 offset:8192
  ds_read_b64_tr_b16 v[18:19], v3 offset:8704
  v_and_b32 v71, 0xff, v70
  s_lshl_b32 s55, s86, 10
  s_lshl_b32 s56, s59, 5
  s_add_u32 s55, s55, s56
  s_waitcnt lgkmcnt(6)
  v_mfma_f32_32x32x16_bf16 v[32:47], v[196:199], v[20:23], v[32:47]
  ds_read_b64_tr_b16 v[20:21], v3 offset:10240
  ds_read_b64_tr_b16 v[22:23], v3 offset:10752
  s_add_u32 s55, s55, 16384
  v_add_u32 v70, s55, v70
  s_lshl_b32 s55, s57, 10
  s_lshl_b32 s56, s58, 8
  s_waitcnt lgkmcnt(6)
  v_mfma_f32_32x32x16_bf16 v[32:47], v[200:203], v[24:27], v[32:47]
  ds_read_b64_tr_b16 v[24:25], v3 offset:12288
  ds_read_b64_tr_b16 v[26:27], v3 offset:12800
  s_add_u32 s55, s55, s56
  s_add_u32 s55, s55, 16416
  v_add_u32 v71, s55, v71
  s_mul_i32 s87, s61, 80
  s_waitcnt lgkmcnt(6)
  v_mfma_f32_32x32x16_bf16 v[32:47], v[204:207], v[28:31], v[32:47]
  s_waitcnt vmcnt(4)
  s_barrier
  ds_read_b64_tr_b16 v[28:29], v3 offset:14336
  ds_read_b64_tr_b16 v[30:31], v3 offset:14848
  s_waitcnt lgkmcnt(6)
  v_mfma_f32_32x32x16_bf16 v[32:47], v[208:211], v[16:19], v[32:47]
  s_add_u32 m0, s67, 49152
  s_add_u32 s3, s66, 1082368
  buffer_load_dwordx4 v1, s[40:43], s3 offen sc1 lds
  ds_read_b64_tr_b16 v[16:17], v3 offset:16384
  ds_read_b64_tr_b16 v[18:19], v3 offset:16896
  s_lshl_b32 s55, s86, 4
  s_add_u32 s55, s55, s87
  v_lshrrev_b32 v76, 4, v0
  v_lshl_add_u32 v72, v76, 2, s55
  s_waitcnt lgkmcnt(6)
  v_mfma_f32_32x32x16_bf16 v[32:47], v[212:215], v[20:23], v[32:47]
  s_add_u32 m0, s67, 50176
  s_add_u32 s3, s66, 1116160
  buffer_load_dwordx4 v1, s[40:43], s3 offen sc1 lds
  ds_read_b64_tr_b16 v[20:21], v3 offset:18432
  ds_read_b64_tr_b16 v[22:23], v3 offset:18944
  s_lshl_b32 s55, s57, 4
  s_lshl_b32 s56, s58, 2
  s_add_u32 s55, s55, s56
  s_add_u32 s55, s55, s87
  s_waitcnt lgkmcnt(6)
  v_mfma_f32_32x32x16_bf16 v[32:47], v[216:219], v[24:27], v[32:47]
  ds_read_b64_tr_b16 v[24:25], v3 offset:20480
  ds_read_b64_tr_b16 v[26:27], v3 offset:20992
  v_mov_b32 v73, s55
  s_lshl_b32 s55, s90, 5
  s_lshl_b32 s56, s59, 4
  s_add_u32 s56, s56, s55
  global_load_dwordx2 v[80:81], v79, s[34:35] offset:0 sc1
  global_load_dwordx2 v[82:83], v79, s[34:35] offset:1024 sc1
  global_load_dwordx2 v[84:85], v79, s[34:35] offset:2048 sc1
  global_load_dwordx2 v[88:89], v79, s[34:35] offset:3072 sc1
  s_waitcnt lgkmcnt(6)
  v_mfma_f32_32x32x16_bf16 v[32:47], v[220:223], v[28:31], v[32:47]
  ds_read_b64_tr_b16 v[28:29], v3 offset:22528
  ds_read_b64_tr_b16 v[30:31], v3 offset:23040
  s_add_u32 s55, s55, 16
  s_lshr_b32 s88, s62, 3
  s_lshl_b32 s88, s88, 9
  s_lshl_b32 s89, s53, 3
  s_waitcnt lgkmcnt(6)
  v_mfma_f32_32x32x16_bf16 v[32:47], v[224:227], v[16:19], v[32:47]
  ds_read_b64_tr_b16 v[16:17], v3 offset:24576
  ds_read_b64_tr_b16 v[18:19], v3 offset:25088
  s_add_u32 s88, s88, s89
  v_add_u32 v76, s56, v77
  v_and_b32 v78, 7, v76
  v_lshrrev_b32 v76, 3, v76
  s_waitcnt lgkmcnt(6)
  v_mfma_f32_32x32x16_bf16 v[32:47], v[228:231], v[20:23], v[32:47]
  ds_read_b64_tr_b16 v[20:21], v3 offset:26624
  ds_read_b64_tr_b16 v[22:23], v3 offset:27136
  v_lshl_add_u32 v76, v78, 6, v76
  v_add_u32 v76, s88, v76
  v_mul_u32_u24 v76, 1280, v76
  v_lshl_add_u32 v74, v72, 1, v76
  s_waitcnt lgkmcnt(6)
  v_mfma_f32_32x32x16_bf16 v[32:47], v[232:235], v[24:27], v[32:47]
  ds_read_b64_tr_b16 v[24:25], v3 offset:28672
  ds_read_b64_tr_b16 v[26:27], v3 offset:29184
  v_lshlrev_b32 v72, 2, v72
  v_add_u32 v72, 160256, v72
  v_add_u32 v76, s55, v77
  v_and_b32 v78, 7, v76
  s_waitcnt lgkmcnt(6)
  v_mfma_f32_32x32x16_bf16 v[32:47], v[236:239], v[28:31], v[32:47]
  s_cmp_lg_u32 s36, 0
  s_cbranch_scc1 L_ow_57
  v_cmp_gt_u32 vcc, 10, v8
  s_nop 0
  s_and_b32 vcc_lo, vcc_lo, 0xf
  s_cbranch_scc0 L_polld_59
L_poll_58:
  s_sleep 2
  v_mov_b32 v8, 0
  s_mov_b64 exec, 0xf
  global_atomic_add v8, v7, v8, s[34:35] offset:0 sc0 sc1
  s_mov_b64 exec, -1
  s_waitcnt vmcnt(0)
  v_cmp_gt_u32 vcc, 10, v8
  s_nop 0
  s_and_b32 vcc_lo, vcc_lo, 0xf
  s_cbranch_scc0 L_polld_59
  s_add_u32 s79, s79, 1
  s_cmp_lt_u32 s79, 400000
  s_cbranch_scc1 L_poll_58
L_polld_59:
L_ow_57:
  s_waitcnt vmcnt(8)
  s_barrier
  ds_read_b64_tr_b16 v[28:29], v3 offset:30720
  ds_read_b64_tr_b16 v[30:31], v3 offset:31232
  s_waitcnt lgkmcnt(6)
  v_mfma_f32_32x32x16_bf16 v[32:47], v[240:243], v[16:19], v[32:47]
  s_add_u32 m0, s67, 65536
  s_add_u32 s3, s66, 1623040
  buffer_load_dwordx4 v1, s[40:43], s3 offen sc1 lds
  ds_read_b64_tr_b16 v[16:17], v2 offset:0
  ds_read_b64_tr_b16 v[18:19], v2 offset:512
  v_lshrrev_b32 v76, 3, v76
  v_lshl_add_u32 v76, v78, 6, v76
  v_add_u32 v76, s88, v76
  v_mul_u32_u24 v76, 1280, v76
  global_load_dword v5, v6, s[34:35] offset:0 sc1
  s_waitcnt lgkmcnt(6)
  v_mfma_f32_32x32x16_bf16 v[32:47], v[244:247], v[20:23], v[32:47]
  s_add_u32 m0, s67, 66560
  s_add_u32 s3, s66, 1656832
  buffer_load_dwordx4 v1, s[40:43], s3 offen sc1 lds
  ds_read_b64_tr_b16 v[20:21], v2 offset:2048
  ds_read_b64_tr_b16 v[22:23], v2 offset:2560
  v_lshl_add_u32 v75, v73, 1, v76
  v_lshlrev_b32 v73, 2, v73
  v_add_u32 v73, 160256, v73
  s_waitcnt lgkmcnt(6)
  v_mfma_f32_32x32x16_bf16 v[32:47], v[248:251], v[24:27], v[32:47]
  ds_read_b64_tr_b16 v[24:25], v2 offset:4096
  ds_read_b64_tr_b16 v[26:27], v2 offset:4608
  s_waitcnt lgkmcnt(6)
  v_mfma_f32_32x32x16_bf16 v[32:47], v[252:255], v[28:31], v[32:47]
  ds_read_b64_tr_b16 v[28:29], v2 offset:6144
  ds_read_b64_tr_b16 v[30:31], v2 offset:6656
  s_waitcnt lgkmcnt(6)
  v_mfma_f32_32x32x16_bf16 v[48:63], v[96:99], v[16:19], 0
  ds_read_b64_tr_b16 v[16:17], v2 offset:8192
  ds_read_b64_tr_b16 v[18:19], v2 offset:8704
  s_waitcnt lgkmcnt(6)
  v_mfma_f32_32x32x16_bf16 v[48:63], v[100:103], v[20:23], v[48:63]
  ds_read_b64_tr_b16 v[20:21], v2 offset:10240
  ds_read_b64_tr_b16 v[22:23], v2 offset:10752
  s_waitcnt lgkmcnt(6)
  v_mfma_f32_32x32x16_bf16 v[48:63], v[104:107], v[24:27], v[48:63]
  ds_read_b64_tr_b16 v[24:25], v2 offset:12288
  ds_read_b64_tr_b16 v[26:27], v2 offset:12800
  s_waitcnt lgkmcnt(6)
  v_mfma_f32_32x32x16_bf16 v[48:63], v[108:111], v[28:31], v[48:63]
  s_waitcnt vmcnt(9)
  s_barrier
  ds_read_b64_tr_b16 v[28:29], v2 offset:14336
  ds_read_b64_tr_b16 v[30:31], v2 offset:14848
  s_waitcnt lgkmcnt(6)
  v_mfma_f32_32x32x16_bf16 v[48:63], v[112:115], v[16:19], v[48:63]
  s_add_u32 m0, s67, 81920
  s_add_u32 s3, s66, 2163712
  buffer_load_dwordx4 v1, s[40:43], s3 offen sc1 lds
  ds_read_b64_tr_b16 v[16:17], v2 offset:16384
  ds_read_b64_tr_b16 v[18:19], v2 offset:16896
  s_waitcnt lgkmcnt(6)
  v_mfma_f32_32x32x16_bf16 v[48:63], v[116:119], v[20:23], v[48:63]
  s_add_u32 m0, s67, 82944
  s_add_u32 s3, s66, 2197504
  buffer_load_dwordx4 v1, s[40:43], s3 offen sc1 lds
  ds_read_b64_tr_b16 v[20:21], v2 offset:18432
  ds_read_b64_tr_b16 v[22:23], v2 offset:18944
  s_waitcnt lgkmcnt(6)
  v_mfma_f32_32x32x16_bf16 v[48:63], v[120:123], v[24:27], v[48:63]
  s_add_u32 m0, s64, 0
  s_add_u32 s3, s63, 0
  buffer_load_dwordx4 v4, s[40:43], s3 offen sc1 lds
  ds_read_b64_tr_b16 v[24:25], v2 offset:20480
  ds_read_b64_tr_b16 v[26:27], v2 offset:20992
  s_waitcnt vmcnt(8)
  v_min3_u32 v90, v80, v81, v82
  s_waitcnt vmcnt(7)
  v_min3_u32 v90, v90, v83, v84
  s_waitcnt vmcnt(6)
  v_min3_u32 v90, v90, v85, v88
  v_min_u32 v90, v90, v89
  v_cmp_eq_u32 vcc, 0, v90
  s_nop 0
  s_cbranch_vccz L_cd_61
L_cr_60:
  s_sleep 2
  global_load_dwordx2 v[80:81], v79, s[34:35] offset:0 sc1
  global_load_dwordx2 v[82:83], v79, s[34:35] offset:1024 sc1
  global_load_dwordx2 v[84:85], v79, s[34:35] offset:2048 sc1
  global_load_dwordx2 v[88:89], v79, s[34:35] offset:3072 sc1
  s_waitcnt vmcnt(2)
  v_min3_u32 v90, v80, v81, v82
  s_waitcnt vmcnt(1)
  v_min3_u32 v90, v90, v83, v84
  s_waitcnt vmcnt(0)
  v_min3_u32 v90, v90, v85, v88
  v_min_u32 v90, v90, v89
  v_cmp_eq_u32 vcc, 0, v90
  s_nop 0
  s_cbranch_vccz L_cd_61
  s_add_u32 s79, s79, 1
  s_cmp_lt_u32 s79, 400000
  s_cbranch_scc1 L_cr_60
L_cd_61:
  v_add_f32 v80, v80, v82
  v_add_f32 v81, v81, v83
  v_add_f32 v84, v84, v88
  v_add_f32 v85, v85, v89
  v_add_f32 v80, v80, v84
  v_add_f32 v81, v81, v85
  v_mov_b32 v82, v80
  v_mov_b32 v83, v81
  v_cmp_gt_u32 vcc, 32, v0
  v_permlane32_swap_b32 v80, v82
  v_permlane32_swap_b32 v81, v83
  v_mov_b32 v94, 0
  v_mov_b32 v95, 0
  v_add_f32 v80, v80, v82
  v_add_f32 v81, v81, v83
  v_cvt_pk_bf16_f32 v82, v80, v81
  v_lshlrev_b32 v83, 16, v82
  v_and_b32 v84, 0xffff0000, v82
  v_sub_f32 v80, v80, v83
  v_sub_f32 v81, v81, v84
  v_cvt_pk_bf16_f32 v80, v83, v80
  v_cvt_pk_bf16_f32 v81, v84, v81
  v_cndmask_b32 v92, 0, v80, vcc
  v_cndmask_b32 v93, 0, v81, vcc
  s_waitcnt lgkmcnt(6)
  v_mfma_f32_32x32x16_bf16 v[48:63], v[124:127], v[28:31], v[48:63]
  ds_read_b64_tr_b16 v[28:29], v2 offset:22528
  ds_read_b64_tr_b16 v[30:31], v2 offset:23040
  s_waitcnt lgkmcnt(6)
  v_mfma_f32_32x32x16_bf16 v[48:63], v[128:131], v[16:19], v[48:63]
  ds_read_b64_tr_b16 v[16:17], v2 offset:24576
  ds_read_b64_tr_b16 v[18:19], v2 offset:25088
  s_waitcnt lgkmcnt(6)
  v_mfma_f32_32x32x16_bf16 v[48:63], v[132:135], v[20:23], v[48:63]
  ds_read_b64_tr_b16 v[20:21], v2 offset:26624
  ds_read_b64_tr_b16 v[22:23], v2 offset:27136
  s_waitcnt lgkmcnt(6)
  v_mfma_f32_32x32x16_bf16 v[48:63], v[136:139], v[24:27], v[48:63]
  ds_read_b64_tr_b16 v[24:25], v2 offset:28672
  ds_read_b64_tr_b16 v[26:27], v2 offset:29184
  s_waitcnt vmcnt(4)
  v_cmp_gt_u32 vcc, 0x10000, v5
  s_nop 0
  s_cbranch_vccz L_polld_63
L_poll_62:
  s_sleep 2
  global_load_dword v5, v6, s[34:35] offset:0 sc1
  s_waitcnt vmcnt(0)
  v_cmp_gt_u32 vcc, 0x10000, v5
  s_nop 0
  s_cbranch_vccz L_polld_63
  s_add_u32 s79, s79, 1
  s_cmp_lt_u32 s79, 400000
  s_cbranch_scc1 L_poll_62
L_polld_63:
  s_mov_b32 s55, 0x01000100
  s_mov_b32 s56, 0x03020302
  v_perm_b32 v12, v5, v5, s55
  v_perm_b32 v13, v5, v5, s56
  v_xor_b32 v12, 0x80008000, v12
  v_and_b32 v11, 0xffff0000, v5
  v_rcp_f32 v10, v11
  v_mfma_f32_32x32x16_bf16 v[32:47], v[92:95], v[12:15], v[32:47]
  s_waitcnt lgkmcnt(6)
  v_mfma_f32_32x32x16_bf16 v[48:63], v[140:143], v[28:31], v[48:63]
  s_barrier
  ds_read_b64_tr_b16 v[28:29], v2 offset:30720
  ds_read_b64_tr_b16 v[30:31], v2 offset:31232
  v_mul_f32 v11, v11, v11
  v_mul_f32 v9, v10, v10
  v_mul_f32 v10, 0xc0135761, v10
  s_waitcnt lgkmcnt(6)
  v_mfma_f32_32x32x16_bf16 v[48:63], v[144:147], v[16:19], v[48:63]
  s_add_u32 m0, s67, 16384
  s_add_u32 s3, s66, 2048
  buffer_load_dwordx4 v1, s[40:43], s3 offen sc1 lds
  ds_read_b64_tr_b16 v[16:17], v2 offset:32768
  ds_read_b64_tr_b16 v[18:19], v2 offset:33280
  v_mul_f32 v9, 0x3d372713, v9
  v_mul_f32 v9, v9, v10
  s_waitcnt lgkmcnt(6)
  v_mfma_f32_32x32x16_bf16 v[48:63], v[148:151], v[20:23], v[48:63]
  s_add_u32 m0, s67, 17408
  s_add_u32 s3, s66, 35840
  buffer_load_dwordx4 v1, s[40:43], s3 offen sc1 lds
  ds_read_b64_tr_b16 v[20:21], v2 offset:34816
  ds_read_b64_tr_b16 v[22:23], v2 offset:35328
  s_waitcnt lgkmcnt(6)
  v_mfma_f32_32x32x16_bf16 v[48:63], v[152:155], v[24:27], v[48:63]
  s_add_u32 m0, s64, 1024
  s_add_u32 s3, s63, 1024
  buffer_load_dwordx4 v4, s[40:43], s3 offen sc1 lds
  ds_read_b64_tr_b16 v[24:25], v2 offset:36864
  ds_read_b64_tr_b16 v[26:27], v2 offset:37376
  v_mul_f32 v80, v32, v32
  v_mul_f32 v81, v33, v33
  v_mul_f32 v82, v34, v34
  v_mul_f32 v83, v35, v35
  s_waitcnt lgkmcnt(6)
  v_mfma_f32_32x32x16_bf16 v[48:63], v[156:159], v[28:31], v[48:63]
  ds_read_b64_tr_b16 v[28:29], v2 offset:38912
  ds_read_b64_tr_b16 v[30:31], v2 offset:39424
  v_fma_f32 v80, v80, v9, v10
  v_fma_f32 v81, v81, v9, v10
  v_fma_f32 v82, v82, v9, v10
  s_waitcnt lgkmcnt(6)
  v_mfma_f32_32x32x16_bf16 v[48:63], v[160:163], v[16:19], v[48:63]
  ds_read_b64_tr_b16 v[16:17], v2 offset:40960
  ds_read_b64_tr_b16 v[18:19], v2 offset:41472
  v_fma_f32 v83, v83, v9, v10
  v_mul_f32 v80, v80, v32
  v_mul_f32 v81, v81, v33
  v_mul_f32 v82, v82, v34
  s_waitcnt lgkmcnt(6)
  v_mfma_f32_32x32x16_bf16 v[48:63], v[164:167], v[20:23], v[48:63]
  ds_read_b64_tr_b16 v[20:21], v2 offset:43008
  ds_read_b64_tr_b16 v[22:23], v2 offset:43520
  v_mul_f32 v83, v83, v35
  v_exp_f32 v80, v80
  s_waitcnt lgkmcnt(6)
  v_mfma_f32_32x32x16_bf16 v[48:63], v[168:171], v[24:27], v[48:63]
  ds_read_b64_tr_b16 v[24:25], v2 offset:45056
  ds_read_b64_tr_b16 v[26:27], v2 offset:45568
  v_exp_f32 v81, v81
  v_exp_f32 v82, v82
  s_waitcnt lgkmcnt(6)
  v_mfma_f32_32x32x16_bf16 v[48:63], v[172:175], v[28:31], v[48:63]
  s_waitcnt vmcnt(6)
  s_barrier
  ds_read_b64_tr_b16 v[28:29], v2 offset:47104
  ds_read_b64_tr_b16 v[30:31], v2 offset:47616
  v_exp_f32 v83, v83
  v_mul_f32 v40, v40, v32
  s_waitcnt lgkmcnt(6)
  v_mfma_f32_32x32x16_bf16 v[48:63], v[176:179], v[16:19], v[48:63]
  s_add_u32 m0, s67, 32768
  s_add_u32 s3, s66, 542720
  buffer_load_dwordx4 v1, s[40:43], s3 offen sc1 lds
  ds_read_b64_tr_b16 v[16:17], v3 offset:0
  ds_read_b64_tr_b16 v[18:19], v3 offset:512
  v_mul_f32 v41, v41, v33
  v_mul_f32 v42, v42, v34
  v_mul_f32 v43, v43, v35
  v_fma_f32 v80, v80, v11, v11
  s_waitcnt lgkmcnt(6)
  v_mfma_f32_32x32x16_bf16 v[48:63], v[180:183], v[20:23], v[48:63]
  s_add_u32 m0, s67, 33792
  s_add_u32 s3, s66, 576512
  buffer_load_dwordx4 v1, s[40:43], s3 offen sc1 lds
  ds_read_b64_tr_b16 v[20:21], v3 offset:2048
  ds_read_b64_tr_b16 v[22:23], v3 offset:2560
  v_fma_f32 v81, v81, v11, v11
  v_fma_f32 v82, v82, v11, v11
  v_fma_f32 v83, v83, v11, v11
  s_waitcnt lgkmcnt(6)
  v_mfma_f32_32x32x16_bf16 v[48:63], v[184:187], v[24:27], v[48:63]
  s_add_u32 m0, s64, 2048
  s_add_u32 s3, s63, 2048
  buffer_load_dwordx4 v4, s[40:43], s3 offen sc1 lds
  ds_read_b64_tr_b16 v[24:25], v3 offset:4096
  ds_read_b64_tr_b16 v[26:27], v3 offset:4608
  v_rcp_f32 v80, v80
  v_rcp_f32 v81, v81
  s_waitcnt lgkmcnt(6)
  v_mfma_f32_32x32x16_bf16 v[48:63], v[188:191], v[28:31], v[48:63]
  ds_read_b64_tr_b16 v[28:29], v3 offset:6144
  ds_read_b64_tr_b16 v[30:31], v3 offset:6656
  v_rcp_f32 v82, v82
  v_rcp_f32 v83, v83
  s_waitcnt lgkmcnt(6)
  v_mfma_f32_32x32x16_bf16 v[48:63], v[192:195], v[16:19], v[48:63]
  ds_read_b64_tr_b16 v[16:17], v3 offset:8192
  ds_read_b64_tr_b16 v[18:19], v3 offset:8704
  v_mul_f32 v40, v40, v80
  v_mul_f32 v41, v41, v81
  v_mul_f32 v42, v42, v82
  s_waitcnt lgkmcnt(6)
  v_mfma_f32_32x32x16_bf16 v[48:63], v[196:199], v[20:23], v[48:63]
  ds_read_b64_tr_b16 v[20:21], v3 offset:10240
  ds_read_b64_tr_b16 v[22:23], v3 offset:10752
  v_mul_f32 v43, v43, v83
  v_cvt_pk_bf16_f32 v88, v40, v41
  v_cvt_pk_bf16_f32 v89, v42, v43
  s_waitcnt lgkmcnt(6)
  v_mfma_f32_32x32x16_bf16 v[48:63], v[200:203], v[24:27], v[48:63]
  ds_read_b64_tr_b16 v[24:25], v3 offset:12288
  ds_read_b64_tr_b16 v[26:27], v3 offset:12800
  v_mul_f32 v80, v36, v36
  v_mul_f32 v81, v37, v37
  v_mul_f32 v82, v38, v38
  v_mul_f32 v83, v39, v39
  s_waitcnt lgkmcnt(6)
  v_mfma_f32_32x32x16_bf16 v[48:63], v[204:207], v[28:31], v[48:63]
  s_waitcnt vmcnt(7)
  s_barrier
  ds_read_b64_tr_b16 v[28:29], v3 offset:14336
  ds_read_b64_tr_b16 v[30:31], v3 offset:14848
  global_load_dword v5, v6, s[34:35] offset:2048 sc1
  v_fma_f32 v80, v80, v9, v10
  v_fma_f32 v81, v81, v9, v10
  v_fma_f32 v82, v82, v9, v10
  s_waitcnt lgkmcnt(6)
  v_mfma_f32_32x32x16_bf16 v[48:63], v[208:211], v[16:19], v[48:63]
  s_add_u32 m0, s67, 49152
  s_add_u32 s3, s66, 1083392
  buffer_load_dwordx4 v1, s[40:43], s3 offen sc1 lds
  ds_read_b64_tr_b16 v[16:17], v3 offset:16384
  ds_read_b64_tr_b16 v[18:19], v3 offset:16896
  v_fma_f32 v83, v83, v9, v10
  v_mul_f32 v80, v80, v36
  v_mul_f32 v81, v81, v37
  v_mul_f32 v82, v82, v38
  s_waitcnt lgkmcnt(6)
  v_mfma_f32_32x32x16_bf16 v[48:63], v[212:215], v[20:23], v[48:63]
  s_add_u32 m0, s67, 50176
  s_add_u32 s3, s66, 1117184
  buffer_load_dwordx4 v1, s[40:43], s3 offen sc1 lds
  ds_read_b64_tr_b16 v[20:21], v3 offset:18432
  ds_read_b64_tr_b16 v[22:23], v3 offset:18944
  v_mul_f32 v83, v83, v39
  v_exp_f32 v80, v80
  s_waitcnt lgkmcnt(6)
  v_mfma_f32_32x32x16_bf16 v[48:63], v[216:219], v[24:27], v[48:63]
  s_add_u32 m0, s64, 3072
  s_add_u32 s3, s63, 3072
  buffer_load_dwordx4 v4, s[40:43], s3 offen sc1 lds
  ds_read_b64_tr_b16 v[24:25], v3 offset:20480
  ds_read_b64_tr_b16 v[26:27], v3 offset:20992
  v_exp_f32 v81, v81
  v_exp_f32 v82, v82
  s_waitcnt lgkmcnt(6)
  v_mfma_f32_32x32x16_bf16 v[48:63], v[220:223], v[28:31], v[48:63]
  ds_read_b64_tr_b16 v[28:29], v3 offset:22528
  ds_read_b64_tr_b16 v[30:31], v3 offset:23040
  v_exp_f32 v83, v83
  v_mul_f32 v44, v44, v36
  s_waitcnt lgkmcnt(6)
  v_mfma_f32_32x32x16_bf16 v[48:63], v[224:227], v[16:19], v[48:63]
  ds_read_b64_tr_b16 v[16:17], v3 offset:24576
  ds_read_b64_tr_b16 v[18:19], v3 offset:25088
  v_mul_f32 v45, v45, v37
  v_mul_f32 v46, v46, v38
  v_mul_f32 v47, v47, v39
  v_fma_f32 v80, v80, v11, v11
  s_waitcnt lgkmcnt(6)
  v_mfma_f32_32x32x16_bf16 v[48:63], v[228:231], v[20:23], v[48:63]
  ds_read_b64_tr_b16 v[20:21], v3 offset:26624
  ds_read_b64_tr_b16 v[22:23], v3 offset:27136
  v_fma_f32 v81, v81, v11, v11
  v_fma_f32 v82, v82, v11, v11
  v_fma_f32 v83, v83, v11, v11
  s_waitcnt lgkmcnt(6)
  v_mfma_f32_32x32x16_bf16 v[48:63], v[232:235], v[24:27], v[48:63]
  ds_read_b64_tr_b16 v[24:25], v3 offset:28672
  ds_read_b64_tr_b16 v[26:27], v3 offset:29184
  v_rcp_f32 v80, v80
  v_rcp_f32 v81, v81
  s_waitcnt lgkmcnt(6)
  v_mfma_f32_32x32x16_bf16 v[48:63], v[236:239], v[28:31], v[48:63]
  s_waitcnt vmcnt(8)
  s_barrier
  ds_read_b64_tr_b16 v[28:29], v3 offset:30720
  ds_read_b64_tr_b16 v[30:31], v3 offset:31232
  v_rcp_f32 v82, v82
  v_rcp_f32 v83, v83
  s_waitcnt lgkmcnt(6)
  v_mfma_f32_32x32x16_bf16 v[48:63], v[240:243], v[16:19], v[48:63]
  s_add_u32 m0, s67, 65536
  s_add_u32 s3, s66, 1624064
  buffer_load_dwordx4 v1, s[40:43], s3 offen sc1 lds
  ds_read_b64_tr_b16 v[16:17], v2 offset:0
  ds_read_b64_tr_b16 v[18:19], v2 offset:512
  v_mul_f32 v44, v44, v80
  v_mul_f32 v45, v45, v81
  v_mul_f32 v46, v46, v82
  s_waitcnt lgkmcnt(6)
  v_mfma_f32_32x32x16_bf16 v[48:63], v[244:247], v[20:23], v[48:63]
  s_add_u32 m0, s67, 66560
  s_add_u32 s3, s66, 1657856
  buffer_load_dwordx4 v1, s[40:43], s3 offen sc1 lds
  ds_read_b64_tr_b16 v[20:21], v2 offset:2048
  ds_read_b64_tr_b16 v[22:23], v2 offset:2560
  v_mul_f32 v47, v47, v83
  v_cvt_pk_bf16_f32 v90, v44, v45
  v_cvt_pk_bf16_f32 v91, v46, v47
  s_waitcnt lgkmcnt(6)
  v_mfma_f32_32x32x16_bf16 v[48:63], v[248:251], v[24:27], v[48:63]
  s_add_u32 m0, s64, 4096
  s_add_u32 s3, s63, 4096
  buffer_load_dwordx4 v4, s[40:43], s3 offen sc1 lds
  ds_read_b64_tr_b16 v[24:25], v2 offset:4096
  ds_read_b64_tr_b16 v[26:27], v2 offset:4608
  s_add_u32 s3, s65, 0
  buffer_store_dwordx4 v[88:91], v4, s[40:43], s3 offen sc1
  s_waitcnt lgkmcnt(6)
  v_mfma_f32_32x32x16_bf16 v[48:63], v[252:255], v[28:31], v[48:63]
  ds_read_b64_tr_b16 v[28:29], v2 offset:6144
  ds_read_b64_tr_b16 v[30:31], v2 offset:6656
  s_waitcnt lgkmcnt(6)
  v_mfma_f32_32x32x16_bf16 v[32:47], v[96:99], v[16:19], 0
  ds_read_b64_tr_b16 v[16:17], v2 offset:8192
  ds_read_b64_tr_b16 v[18:19], v2 offset:8704
  s_waitcnt lgkmcnt(6)
  v_mfma_f32_32x32x16_bf16 v[32:47], v[100:103], v[20:23], v[32:47]
  ds_read_b64_tr_b16 v[20:21], v2 offset:10240
  ds_read_b64_tr_b16 v[22:23], v2 offset:10752
  s_waitcnt vmcnt(7)
  v_cmp_gt_u32 vcc, 0x10000, v5
  s_nop 0
  s_cbranch_vccz L_polld_65
L_poll_64:
  s_sleep 2
  global_load_dword v5, v6, s[34:35] offset:2048 sc1
  s_waitcnt vmcnt(0)
  v_cmp_gt_u32 vcc, 0x10000, v5
  s_nop 0
  s_cbranch_vccz L_polld_65
  s_add_u32 s79, s79, 1
  s_cmp_lt_u32 s79, 400000
  s_cbranch_scc1 L_poll_64
L_polld_65:
  s_mov_b32 s55, 0x01000100
  s_mov_b32 s56, 0x03020302
  v_perm_b32 v12, v5, v5, s55
  v_perm_b32 v13, v5, v5, s56
  v_xor_b32 v12, 0x80008000, v12
  v_and_b32 v11, 0xffff0000, v5
  v_rcp_f32 v10, v11
  v_mfma_f32_32x32x16_bf16 v[48:63], v[92:95], v[12:15], v[48:63]
  s_waitcnt lgkmcnt(6)
  v_mfma_f32_32x32x16_bf16 v[32:47], v[104:107], v[24:27], v[32:47]
  ds_read_b64_tr_b16 v[24:25], v2 offset:12288
  ds_read_b64_tr_b16 v[26:27], v2 offset:12800
  v_mul_f32 v11, v11, v11
  v_mul_f32 v9, v10, v10
  v_mul_f32 v10, 0xc0135761, v10
  s_waitcnt lgkmcnt(6)
  v_mfma_f32_32x32x16_bf16 v[32:47], v[108:111], v[28:31], v[32:47]
  s_barrier
  ds_read_b64_tr_b16 v[28:29], v2 offset:14336
  ds_read_b64_tr_b16 v[30:31], v2 offset:14848
  v_mul_f32 v9, 0x3d372713, v9
  v_mul_f32 v9, v9, v10
  s_waitcnt lgkmcnt(6)
  v_mfma_f32_32x32x16_bf16 v[32:47], v[112:115], v[16:19], v[32:47]
  s_add_u32 m0, s67, 81920
  s_add_u32 s3, s66, 2164736
  buffer_load_dwordx4 v1, s[40:43], s3 offen sc1 lds
  ds_read_b64_tr_b16 v[16:17], v2 offset:16384
  ds_read_b64_tr_b16 v[18:19], v2 offset:16896
  s_waitcnt lgkmcnt(6)
  v_mfma_f32_32x32x16_bf16 v[32:47], v[116:119], v[20:23], v[32:47]
  s_add_u32 m0, s67, 82944
  s_add_u32 s3, s66, 2198528
  buffer_load_dwordx4 v1, s[40:43], s3 offen sc1 lds
  ds_read_b64_tr_b16 v[20:21], v2 offset:18432
  ds_read_b64_tr_b16 v[22:23], v2 offset:18944
  v_mul_f32 v80, v48, v48
  v_mul_f32 v81, v49, v49
  v_mul_f32 v82, v50, v50
  v_mul_f32 v83, v51, v51
  v_fma_f32 v80, v80, v9, v10
  s_waitcnt lgkmcnt(6)
  v_mfma_f32_32x32x16_bf16 v[32:47], v[120:123], v[24:27], v[32:47]
  s_add_u32 m0, s60, 0
  s_add_u32 s3, s63, 40960
  buffer_load_dwordx4 v4, s[40:43], s3 offen sc1 lds
  ds_read_b64_tr_b16 v[24:25], v2 offset:20480
  ds_read_b64_tr_b16 v[26:27], v2 offset:20992
  v_fma_f32 v81, v81, v9, v10
  v_fma_f32 v82, v82, v9, v10
  v_fma_f32 v83, v83, v9, v10
  v_mul_f32 v80, v80, v48
  s_waitcnt lgkmcnt(6)
  v_mfma_f32_32x32x16_bf16 v[32:47], v[124:127], v[28:31], v[32:47]
  ds_read_b64_tr_b16 v[28:29], v2 offset:22528
  ds_read_b64_tr_b16 v[30:31], v2 offset:23040
  v_mul_f32 v81, v81, v49
  v_mul_f32 v82, v82, v50
  v_mul_f32 v83, v83, v51
  v_exp_f32 v80, v80
  s_waitcnt lgkmcnt(6)
  v_mfma_f32_32x32x16_bf16 v[32:47], v[128:131], v[16:19], v[32:47]
  ds_read_b64_tr_b16 v[16:17], v2 offset:24576
  ds_read_b64_tr_b16 v[18:19], v2 offset:25088
  v_exp_f32 v81, v81
  v_exp_f32 v82, v82
  s_waitcnt lgkmcnt(6)
  v_mfma_f32_32x32x16_bf16 v[32:47], v[132:135], v[20:23], v[32:47]
  ds_read_b64_tr_b16 v[20:21], v2 offset:26624
  ds_read_b64_tr_b16 v[22:23], v2 offset:27136
  v_exp_f32 v83, v83
  v_mul_f32 v56, v56, v48
  s_waitcnt lgkmcnt(6)
  v_mfma_f32_32x32x16_bf16 v[32:47], v[136:139], v[24:27], v[32:47]
  ds_read_b64_tr_b16 v[24:25], v2 offset:28672
  ds_read_b64_tr_b16 v[26:27], v2 offset:29184
  v_mul_f32 v57, v57, v49
  v_mul_f32 v58, v58, v50
  v_mul_f32 v59, v59, v51
  v_fma_f32 v80, v80, v11, v11
  v_fma_f32 v81, v81, v11, v11
  s_waitcnt lgkmcnt(6)
  v_mfma_f32_32x32x16_bf16 v[32:47], v[140:143], v[28:31], v[32:47]
  s_waitcnt vmcnt(3)
  s_barrier
  s_cmp_lg_u32 s36, 0
  s_cbranch_scc1 L_ow_66
  s_add_u32 s55, s92, 0
  s_lshl_b32 s55, s55, 7
  s_add_u32 s55, s55, 86016
  v_mov_b32 v84, s55
  v_mov_b32 v85, 1
  s_mov_b64 exec, 1
  global_atomic_add v84, v85, s[34:35] sc1
  s_mov_b64 exec, -1
L_ow_66:
  ds_read_b64_tr_b16 v[28:29], v2 offset:30720
  ds_read_b64_tr_b16 v[30:31], v2 offset:31232
  v_fma_f32 v82, v82, v11, v11
  v_fma_f32 v83, v83, v11, v11
  v_rcp_f32 v80, v80
  s_waitcnt lgkmcnt(6)
  v_mfma_f32_32x32x16_bf16 v[32:47], v[144:147], v[16:19], v[32:47]
  s_add_u32 m0, s67, 16384
  s_add_u32 s3, s66, 3072
  buffer_load_dwordx4 v1, s[40:43], s3 offen sc1 lds
  ds_read_b64_tr_b16 v[16:17], v2 offset:32768
  ds_read_b64_tr_b16 v[18:19], v2 offset:33280
  v_rcp_f32 v81, v81
  v_rcp_f32 v82, v82
  s_waitcnt lgkmcnt(6)
  v_mfma_f32_32x32x16_bf16 v[32:47], v[148:151], v[20:23], v[32:47]
  s_add_u32 m0, s67, 17408
  s_add_u32 s3, s66, 36864
  buffer_load_dwordx4 v1, s[40:43], s3 offen sc1 lds
  ds_read_b64_tr_b16 v[20:21], v2 offset:34816
  ds_read_b64_tr_b16 v[22:23], v2 offset:35328
  v_rcp_f32 v83, v83
  v_mul_f32 v56, v56, v80
  v_mul_f32 v57, v57, v81
  s_waitcnt lgkmcnt(6)
  v_mfma_f32_32x32x16_bf16 v[32:47], v[152:155], v[24:27], v[32:47]
  s_add_u32 m0, s60, 1024
  s_add_u32 s3, s63, 41984
  buffer_load_dwordx4 v4, s[40:43], s3 offen sc1 lds
  ds_read_b64_tr_b16 v[24:25], v2 offset:36864
  ds_read_b64_tr_b16 v[26:27], v2 offset:37376
  v_mul_f32 v58, v58, v82
  v_mul_f32 v59, v59, v83
  v_cvt_pk_bf16_f32 v88, v56, v57
  v_cvt_pk_bf16_f32 v89, v58, v59
  s_waitcnt lgkmcnt(6)
  v_mfma_f32_32x32x16_bf16 v[32:47], v[156:159], v[28:31], v[32:47]
  ds_read_b64_tr_b16 v[28:29], v2 offset:38912
  ds_read_b64_tr_b16 v[30:31], v2 offset:39424
  v_mul_f32 v80, v52, v52
  v_mul_f32 v81, v53, v53
  v_mul_f32 v82, v54, v54
  v_mul_f32 v83, v55, v55
  v_fma_f32 v80, v80, v9, v10
  s_waitcnt lgkmcnt(6)
  v_mfma_f32_32x32x16_bf16 v[32:47], v[160:163], v[16:19], v[32:47]
  ds_read_b64_tr_b16 v[16:17], v2 offset:40960
  ds_read_b64_tr_b16 v[18:19], v2 offset:41472
  v_fma_f32 v81, v81, v9, v10
  v_fma_f32 v82, v82, v9, v10
  v_fma_f32 v83, v83, v9, v10
  v_mul_f32 v80, v80, v52
  s_waitcnt lgkmcnt(6)
  v_mfma_f32_32x32x16_bf16 v[32:47], v[164:167], v[20:23], v[32:47]
  ds_read_b64_tr_b16 v[20:21], v2 offset:43008
  ds_read_b64_tr_b16 v[22:23], v2 offset:43520
  v_mul_f32 v81, v81, v53
  v_mul_f32 v82, v82, v54
  v_mul_f32 v83, v83, v55
  v_exp_f32 v80, v80
  s_waitcnt lgkmcnt(6)
  v_mfma_f32_32x32x16_bf16 v[32:47], v[168:171], v[24:27], v[32:47]
  ds_read_b64_tr_b16 v[24:25], v2 offset:45056
  ds_read_b64_tr_b16 v[26:27], v2 offset:45568
  v_exp_f32 v81, v81
  v_exp_f32 v82, v82
  s_waitcnt lgkmcnt(6)
  v_mfma_f32_32x32x16_bf16 v[32:47], v[172:175], v[28:31], v[32:47]
  s_barrier
  ds_read_b64_tr_b16 v[28:29], v2 offset:47104
  ds_read_b64_tr_b16 v[30:31], v2 offset:47616
  v_exp_f32 v83, v83
  v_mul_f32 v60, v60, v52
  s_waitcnt lgkmcnt(6)
  v_mfma_f32_32x32x16_bf16 v[32:47], v[176:179], v[16:19], v[32:47]
  s_add_u32 m0, s67, 32768
  s_add_u32 s3, s66, 543744
  buffer_load_dwordx4 v1, s[40:43], s3 offen sc1 lds
  ds_read_b64_tr_b16 v[16:17], v3 offset:0
  ds_read_b64_tr_b16 v[18:19], v3 offset:512
  v_mul_f32 v61, v61, v53
  v_mul_f32 v62, v62, v54
  v_mul_f32 v63, v63, v55
  v_fma_f32 v80, v80, v11, v11
  v_fma_f32 v81, v81, v11, v11
  s_waitcnt lgkmcnt(6)
  v_mfma_f32_32x32x16_bf16 v[32:47], v[180:183], v[20:23], v[32:47]
  s_add_u32 m0, s67, 33792
  s_add_u32 s3, s66, 577536
  buffer_load_dwordx4 v1, s[40:43], s3 offen sc1 lds
  ds_read_b64_tr_b16 v[20:21], v3 offset:2048
  ds_read_b64_tr_b16 v[22:23], v3 offset:2560
  v_fma_f32 v82, v82, v11, v11
  v_fma_f32 v83, v83, v11, v11
  v_rcp_f32 v80, v80
  s_waitcnt lgkmcnt(6)
  v_mfma_f32_32x32x16_bf16 v[32:47], v[184:187], v[24:27], v[32:47]
  s_add_u32 m0, s60, 2048
  s_add_u32 s3, s63, 43008
  buffer_load_dwordx4 v4, s[40:43], s3 offen sc1 lds
  ds_read_b64_tr_b16 v[24:25], v3 offset:4096
  ds_read_b64_tr_b16 v[26:27], v3 offset:4608
  v_rcp_f32 v81, v81
  v_rcp_f32 v82, v82
  s_waitcnt lgkmcnt(6)
  v_mfma_f32_32x32x16_bf16 v[32:47], v[188:191], v[28:31], v[32:47]
  ds_read_b64_tr_b16 v[28:29], v3 offset:6144
  ds_read_b64_tr_b16 v[30:31], v3 offset:6656
  v_rcp_f32 v83, v83
  v_mul_f32 v60, v60, v80
  v_mul_f32 v61, v61, v81
  s_waitcnt lgkmcnt(6)
  v_mfma_f32_32x32x16_bf16 v[32:47], v[192:195], v[16:19], v[32:47]
  ds_read_b64_tr_b16 v[16:17], v3 offset:8192
  ds_read_b64_tr_b16 v[18:19], v3 offset:8704
  v_mul_f32 v62, v62, v82
  v_mul_f32 v63, v63, v83
  v_cvt_pk_bf16_f32 v90, v60, v61
  v_cvt_pk_bf16_f32 v91, v62, v63
  s_waitcnt lgkmcnt(6)
  v_mfma_f32_32x32x16_bf16 v[32:47], v[196:199], v[20:23], v[32:47]
  ds_read_b64_tr_b16 v[20:21], v3 offset:10240
  ds_read_b64_tr_b16 v[22:23], v3 offset:10752
  s_add_u32 s3, s65, 1769472
  buffer_store_dwordx4 v[88:91], v4, s[40:43], s3 offen sc1
  s_waitcnt lgkmcnt(6)
  v_mfma_f32_32x32x16_bf16 v[32:47], v[200:203], v[24:27], v[32:47]
  ds_read_b64_tr_b16 v[24:25], v3 offset:12288
  ds_read_b64_tr_b16 v[26:27], v3 offset:12800
  s_waitcnt lgkmcnt(6)
  v_mfma_f32_32x32x16_bf16 v[32:47], v[204:207], v[28:31], v[32:47]
  s_waitcnt vmcnt(8)
  s_barrier
  ds_read_b64_tr_b16 v[28:29], v3 offset:14336
  ds_read_b64_tr_b16 v[30:31], v3 offset:14848
  v_add_u32 v6, 4096, v6
  global_load_dword v5, v6, s[34:35] offset:0 sc1
  s_waitcnt lgkmcnt(6)
  v_mfma_f32_32x32x16_bf16 v[32:47], v[208:211], v[16:19], v[32:47]
  s_add_u32 m0, s67, 49152
  s_add_u32 s3, s66, 1084416
  buffer_load_dwordx4 v1, s[40:43], s3 offen sc1 lds
  ds_read_b64_tr_b16 v[16:17], v3 offset:16384
  ds_read_b64_tr_b16 v[18:19], v3 offset:16896
  s_waitcnt lgkmcnt(6)
  v_mfma_f32_32x32x16_bf16 v[32:47], v[212:215], v[20:23], v[32:47]
  s_add_u32 m0, s67, 50176
  s_add_u32 s3, s66, 1118208
  buffer_load_dwordx4 v1, s[40:43], s3 offen sc1 lds
  ds_read_b64_tr_b16 v[20:21], v3 offset:18432
  ds_read_b64_tr_b16 v[22:23], v3 offset:18944
  s_waitcnt lgkmcnt(6)
  v_mfma_f32_32x32x16_bf16 v[32:47], v[216:219], v[24:27], v[32:47]
  s_add_u32 m0, s60, 3072
  s_add_u32 s3, s63, 44032
  buffer_load_dwordx4 v4, s[40:43], s3 offen sc1 lds
  ds_read_b64_tr_b16 v[24:25], v3 offset:20480
  ds_read_b64_tr_b16 v[26:27], v3 offset:20992
  s_waitcnt lgkmcnt(6)
  v_mfma_f32_32x32x16_bf16 v[32:47], v[220:223], v[28:31], v[32:47]
  ds_read_b64_tr_b16 v[28:29], v3 offset:22528
  ds_read_b64_tr_b16 v[30:31], v3 offset:23040
  s_waitcnt lgkmcnt(6)
  v_mfma_f32_32x32x16_bf16 v[32:47], v[224:227], v[16:19], v[32:47]
  ds_read_b64_tr_b16 v[16:17], v3 offset:24576
  ds_read_b64_tr_b16 v[18:19], v3 offset:25088
  s_waitcnt lgkmcnt(6)
  v_mfma_f32_32x32x16_bf16 v[32:47], v[228:231], v[20:23], v[32:47]
  ds_read_b64_tr_b16 v[20:21], v3 offset:26624
  ds_read_b64_tr_b16 v[22:23], v3 offset:27136
  s_waitcnt lgkmcnt(6)
  v_mfma_f32_32x32x16_bf16 v[32:47], v[232:235], v[24:27], v[32:47]
  ds_read_b64_tr_b16 v[24:25], v3 offset:28672
  ds_read_b64_tr_b16 v[26:27], v3 offset:29184
  s_waitcnt lgkmcnt(6)
  v_mfma_f32_32x32x16_bf16 v[32:47], v[236:239], v[28:31], v[32:47]
  s_waitcnt vmcnt(9)
  s_barrier
  ds_read_b64_tr_b16 v[28:29], v3 offset:30720
  ds_read_b64_tr_b16 v[30:31], v3 offset:31232
  s_waitcnt lgkmcnt(6)
  v_mfma_f32_32x32x16_bf16 v[32:47], v[240:243], v[16:19], v[32:47]
  s_add_u32 m0, s67, 65536
  s_add_u32 s3, s66, 1625088
  buffer_load_dwordx4 v1, s[40:43], s3 offen sc1 lds
  ds_read_b64_tr_b16 v[16:17], v2 offset:0
  ds_read_b64_tr_b16 v[18:19], v2 offset:512
  s_waitcnt lgkmcnt(6)
  v_mfma_f32_32x32x16_bf16 v[32:47], v[244:247], v[20:23], v[32:47]
  s_add_u32 m0, s67, 66560
  s_add_u32 s3, s66, 1658880
  buffer_load_dwordx4 v1, s[40:43], s3 offen sc1 lds
  ds_read_b64_tr_b16 v[20:21], v2 offset:2048
  ds_read_b64_tr_b16 v[22:23], v2 offset:2560
  s_waitcnt lgkmcnt(6)
  v_mfma_f32_32x32x16_bf16 v[32:47], v[248:251], v[24:27], v[32:47]
  s_mov_b32 m0, s78
  s_add_u32 s3, s63, 45056
  buffer_load_dwordx4 v4, s[40:43], s3 offen sc1 lds
  ds_read_b64_tr_b16 v[24:25], v2 offset:4096
  ds_read_b64_tr_b16 v[26:27], v2 offset:4608
  s_waitcnt lgkmcnt(6)
  v_mfma_f32_32x32x16_bf16 v[32:47], v[252:255], v[28:31], v[32:47]
  ds_read_b64_tr_b16 v[28:29], v2 offset:6144
  ds_read_b64_tr_b16 v[30:31], v2 offset:6656
  s_waitcnt lgkmcnt(6)
  v_mfma_f32_32x32x16_bf16 v[48:63], v[96:99], v[16:19], 0
  ds_read_b64_tr_b16 v[16:17], v2 offset:8192
  ds_read_b64_tr_b16 v[18:19], v2 offset:8704
  s_waitcnt lgkmcnt(6)
  v_mfma_f32_32x32x16_bf16 v[48:63], v[100:103], v[20:23], v[48:63]
  ds_read_b64_tr_b16 v[20:21], v2 offset:10240
  ds_read_b64_tr_b16 v[22:23], v2 offset:10752
  s_waitcnt vmcnt(6)
  v_cmp_gt_u32 vcc, 0x10000, v5
  s_nop 0
  s_cbranch_vccz L_polld_68
L_poll_67:
  s_sleep 2
  global_load_dword v5, v6, s[34:35] offset:0 sc1
  s_waitcnt vmcnt(0)
  v_cmp_gt_u32 vcc, 0x10000, v5
  s_nop 0
  s_cbranch_vccz L_polld_68
  s_add_u32 s79, s79, 1
  s_cmp_lt_u32 s79, 400000
  s_cbranch_scc1 L_poll_67
L_polld_68:
  s_mov_b32 s55, 0x01000100
  s_mov_b32 s56, 0x03020302
  v_perm_b32 v12, v5, v5, s55
  v_perm_b32 v13, v5, v5, s56
  v_xor_b32 v12, 0x80008000, v12
  v_and_b32 v11, 0xffff0000, v5
  v_rcp_f32 v10, v11
  v_mfma_f32_32x32x16_bf16 v[32:47], v[92:95], v[12:15], v[32:47]
  s_waitcnt lgkmcnt(6)
  v_mfma_f32_32x32x16_bf16 v[48:63], v[104:107], v[24:27], v[48:63]
  ds_read_b64_tr_b16 v[24:25], v2 offset:12288
  ds_read_b64_tr_b16 v[26:27], v2 offset:12800
  v_mul_f32 v11, v11, v11
  v_mul_f32 v9, v10, v10
  v_mul_f32 v10, 0xc0135761, v10
  s_waitcnt lgkmcnt(6)
  v_mfma_f32_32x32x16_bf16 v[48:63], v[108:111], v[28:31], v[48:63]
  s_barrier
  s_cmp_lg_u32 s36, 0
  s_cbranch_scc1 L_ow_69
  s_add_u32 s55, s92, 8
  s_lshl_b32 s55, s55, 7
  s_add_u32 s55, s55, 86016
  v_mov_b32 v84, s55
  v_mov_b32 v85, 1
  s_mov_b64 exec, 1
  global_atomic_add v84, v85, s[34:35] sc1
  s_mov_b64 exec, -1
L_ow_69:
  ds_read_b64_tr_b16 v[28:29], v2 offset:14336
  ds_read_b64_tr_b16 v[30:31], v2 offset:14848
  v_mul_f32 v9, 0x3d372713, v9
  v_mul_f32 v9, v9, v10
  s_waitcnt lgkmcnt(6)
  v_mfma_f32_32x32x16_bf16 v[48:63], v[112:115], v[16:19], v[48:63]
  s_add_u32 m0, s67, 81920
  s_add_u32 s3, s66, 2165760
  buffer_load_dwordx4 v1, s[40:43], s3 offen sc1 lds
  ds_read_b64_tr_b16 v[16:17], v2 offset:16384
  ds_read_b64_tr_b16 v[18:19], v2 offset:16896
  s_waitcnt lgkmcnt(6)
  v_mfma_f32_32x32x16_bf16 v[48:63], v[116:119], v[20:23], v[48:63]
  s_add_u32 m0, s67, 82944
  s_add_u32 s3, s66, 2199552
  buffer_load_dwordx4 v1, s[40:43], s3 offen sc1 lds
  ds_read_b64_tr_b16 v[20:21], v2 offset:18432
  ds_read_b64_tr_b16 v[22:23], v2 offset:18944
  v_mul_f32 v80, v32, v32
  v_mul_f32 v81, v33, v33
  v_mul_f32 v82, v34, v34
  s_waitcnt lgkmcnt(6)
  v_mfma_f32_32x32x16_bf16 v[48:63], v[120:123], v[24:27], v[48:63]
  ds_read_b64_tr_b16 v[24:25], v2 offset:20480
  ds_read_b64_tr_b16 v[26:27], v2 offset:20992
  s_add_u32 s3, s63, 81920
  buffer_load_dwordx4 v[96:99], v4, s[40:43], s3 offen sc1
  v_mul_f32 v83, v35, v35
  v_fma_f32 v80, v80, v9, v10
  v_fma_f32 v81, v81, v9, v10
  s_waitcnt lgkmcnt(6)
  v_mfma_f32_32x32x16_bf16 v[48:63], v[124:127], v[28:31], v[48:63]
  ds_read_b64_tr_b16 v[28:29], v2 offset:22528
  ds_read_b64_tr_b16 v[30:31], v2 offset:23040
  v_fma_f32 v82, v82, v9, v10
  v_fma_f32 v83, v83, v9, v10
  s_waitcnt lgkmcnt(6)
  v_mfma_f32_32x32x16_bf16 v[48:63], v[128:131], v[16:19], v[48:63]
  ds_read_b64_tr_b16 v[16:17], v2 offset:24576
  ds_read_b64_tr_b16 v[18:19], v2 offset:25088
  s_add_u32 s3, s63, 82944
  buffer_load_dwordx4 v[100:103], v4, s[40:43], s3 offen sc1
  v_mul_f32 v80, v80, v32
  v_mul_f32 v81, v81, v33
  v_mul_f32 v82, v82, v34
  s_waitcnt lgkmcnt(6)
  v_mfma_f32_32x32x16_bf16 v[48:63], v[132:135], v[20:23], v[48:63]
  ds_read_b64_tr_b16 v[20:21], v2 offset:26624
  ds_read_b64_tr_b16 v[22:23], v2 offset:27136
  v_mul_f32 v83, v83, v35
  v_exp_f32 v80, v80
  s_waitcnt lgkmcnt(6)
  v_mfma_f32_32x32x16_bf16 v[48:63], v[136:139], v[24:27], v[48:63]
  ds_read_b64_tr_b16 v[24:25], v2 offset:28672
  ds_read_b64_tr_b16 v[26:27], v2 offset:29184
  s_add_u32 s3, s63, 83968
  buffer_load_dwordx4 v[104:107], v4, s[40:43], s3 offen sc1
  v_exp_f32 v81, v81
  s_waitcnt lgkmcnt(6)
  v_mfma_f32_32x32x16_bf16 v[48:63], v[140:143], v[28:31], v[48:63]
  s_waitcnt vmcnt(9)
  s_barrier
  ds_read_b64_tr_b16 v[28:29], v2 offset:30720
  ds_read_b64_tr_b16 v[30:31], v2 offset:31232
  v_exp_f32 v82, v82
  s_waitcnt lgkmcnt(6)
  v_mfma_f32_32x32x16_bf16 v[48:63], v[144:147], v[16:19], v[48:63]
  ds_read_b64_tr_b16 v[16:17], v2 offset:32768
  ds_read_b64_tr_b16 v[18:19], v2 offset:33280
  s_add_u32 s3, s63, 84992
  buffer_load_dwordx4 v[108:111], v4, s[40:43], s3 offen sc1
  v_exp_f32 v83, v83
  v_mul_f32 v40, v40, v32
  s_waitcnt lgkmcnt(6)
  v_mfma_f32_32x32x16_bf16 v[48:63], v[148:151], v[20:23], v[48:63]
  ds_read_b64_tr_b16 v[20:21], v2 offset:34816
  ds_read_b64_tr_b16 v[22:23], v2 offset:35328
  v_mul_f32 v41, v41, v33
  v_mul_f32 v42, v42, v34
  s_waitcnt lgkmcnt(6)
  v_mfma_f32_32x32x16_bf16 v[48:63], v[152:155], v[24:27], v[48:63]
  ds_read_b64_tr_b16 v[24:25], v2 offset:36864
  ds_read_b64_tr_b16 v[26:27], v2 offset:37376
  s_add_u32 s3, s63, 86016
  buffer_load_dwordx4 v[112:115], v4, s[40:43], s3 offen sc1
  v_mul_f32 v43, v43, v35
  v_fma_f32 v80, v80, v11, v11
  v_fma_f32 v81, v81, v11, v11
  s_waitcnt lgkmcnt(6)
  v_mfma_f32_32x32x16_bf16 v[48:63], v[156:159], v[28:31], v[48:63]
  ds_read_b64_tr_b16 v[28:29], v2 offset:38912
  ds_read_b64_tr_b16 v[30:31], v2 offset:39424
  v_fma_f32 v82, v82, v11, v11
  v_fma_f32 v83, v83, v11, v11
  s_waitcnt lgkmcnt(6)
  v_mfma_f32_32x32x16_bf16 v[48:63], v[160:163], v[16:19], v[48:63]
  ds_read_b64_tr_b16 v[16:17], v2 offset:40960
  ds_read_b64_tr_b16 v[18:19], v2 offset:41472
  v_rcp_f32 v80, v80
  v_rcp_f32 v81, v81
  s_waitcnt lgkmcnt(6)
  v_mfma_f32_32x32x16_bf16 v[48:63], v[164:167], v[20:23], v[48:63]
  ds_read_b64_tr_b16 v[20:21], v2 offset:43008
  ds_read_b64_tr_b16 v[22:23], v2 offset:43520
  s_add_u32 s3, s63, 122880
  buffer_load_dwordx4 v[116:119], v4, s[40:43], s3 offen sc1
  v_rcp_f32 v82, v82
  s_waitcnt lgkmcnt(6)
  v_mfma_f32_32x32x16_bf16 v[48:63], v[168:171], v[24:27], v[48:63]
  ds_read_b64_tr_b16 v[24:25], v2 offset:45056
  ds_read_b64_tr_b16 v[26:27], v2 offset:45568
  v_rcp_f32 v83, v83
  s_waitcnt lgkmcnt(6)
  v_mfma_f32_32x32x16_bf16 v[48:63], v[172:175], v[28:31], v[48:63]
  s_waitcnt vmcnt(9)
  s_barrier
  ds_read_b64_tr_b16 v[28:29], v2 offset:47104
  ds_read_b64_tr_b16 v[30:31], v2 offset:47616
  s_add_u32 s3, s63, 123904
  buffer_load_dwordx4 v[120:123], v4, s[40:43], s3 offen sc1
  v_mul_f32 v40, v40, v80
  v_mul_f32 v41, v41, v81
  v_mul_f32 v42, v42, v82
  s_waitcnt lgkmcnt(6)
  v_mfma_f32_32x32x16_bf16 v[48:63], v[176:179], v[16:19], v[48:63]
  s_cmp_lg_u32 s36, 0
  s_cbranch_scc1 L_ow_70
  v_mov_b32 v8, 0
  s_mov_b64 exec, 0x1
  global_atomic_add v8, v65, v8, s[34:35] offset:0 sc0 sc1
  s_mov_b64 exec, -1
L_ow_70:
  ds_read_b64_tr_b16 v[16:17], v3 offset:0
  ds_read_b64_tr_b16 v[18:19], v3 offset:512
  v_lshrrev_b32 v76, 2, v0
  v_mul_u32_u24 v76, 4224, v76
  v_and_b32 v77, 3, v0
  v_lshl_add_u32 v76, v77, 4, v76
  s_lshl_b32 s55, s86, 4
  s_add_u32 s55, s55, s87
  s_mul_i32 s55, s55, 4224
  s_lshl_b32 s56, s62, 7
  s_lshl_b32 s57, s90, 6
  s_add_u32 s56, s56, s57
  s_add_u32 s56, s56, 7340032
  s_cmp_ge_u32 s36, 5
  s_cselect_b32 s57, 2048, 0
  s_add_u32 s55, s55, s56
  s_add_u32 s55, s55, s57
  s_lshl_b32 s57, s36, 10
  s_add_u32 m0, s57, 16384
  s_nop 0
  buffer_load_dwordx4 v76, s[40:43], s55 offen sc1 lds
  s_add_u32 s55, s36, 3
  s_lshl_b32 s55, s55, 4
  s_add_u32 s55, s55, s87
  s_mul_i32 s55, s55, 4224
  s_add_u32 s55, s55, s56
  s_add_u32 s55, s55, 2048
  s_add_u32 m0, s57, 24576
  s_cmp_lt_u32 s36, 2
  s_cselect_b64 exec, -1, 0
  buffer_load_dwordx4 v76, s[40:43], s55 offen sc1 lds
  s_mov_b64 exec, -1
  v_mul_f32 v43, v43, v83
  v_cvt_pk_bf16_f32 v88, v40, v41
  s_waitcnt lgkmcnt(6)
  v_mfma_f32_32x32x16_bf16 v[48:63], v[180:183], v[20:23], v[48:63]
  ds_read_b64_tr_b16 v[20:21], v3 offset:2048
  ds_read_b64_tr_b16 v[22:23], v3 offset:2560
  s_add_u32 s3, s63, 124928
  buffer_load_dwordx4 v[124:127], v4, s[40:43], s3 offen sc1
  v_cvt_pk_bf16_f32 v89, v42, v43
  v_mul_f32 v80, v36, v36
  v_mul_f32 v81, v37, v37
  s_waitcnt lgkmcnt(6)
  v_mfma_f32_32x32x16_bf16 v[48:63], v[184:187], v[24:27], v[48:63]
  ds_read_b64_tr_b16 v[24:25], v3 offset:4096
  ds_read_b64_tr_b16 v[26:27], v3 offset:4608
  v_mul_f32 v82, v38, v38
  v_mul_f32 v83, v39, v39
  s_waitcnt lgkmcnt(6)
  v_mfma_f32_32x32x16_bf16 v[48:63], v[188:191], v[28:31], v[48:63]
  ds_read_b64_tr_b16 v[28:29], v3 offset:6144
  ds_read_b64_tr_b16 v[30:31], v3 offset:6656
  s_add_u32 s3, s63, 125952
  buffer_load_dwordx4 v[128:131], v4, s[40:43], s3 offen sc1
  v_fma_f32 v80, v80, v9, v10
  v_fma_f32 v81, v81, v9, v10
  v_fma_f32 v82, v82, v9, v10
  s_waitcnt lgkmcnt(6)
  v_mfma_f32_32x32x16_bf16 v[48:63], v[192:195], v[16:19], v[48:63]
  ds_read_b64_tr_b16 v[16:17], v3 offset:8192
  ds_read_b64_tr_b16 v[18:19], v3 offset:8704
  v_fma_f32 v83, v83, v9, v10
  v_mul_f32 v80, v80, v36
  s_waitcnt lgkmcnt(6)
  v_mfma_f32_32x32x16_bf16 v[48:63], v[196:199], v[20:23], v[48:63]
  ds_read_b64_tr_b16 v[20:21], v3 offset:10240
  ds_read_b64_tr_b16 v[22:23], v3 offset:10752
  s_add_u32 s3, s63, 126976
  buffer_load_dwordx4 v[132:135], v4, s[40:43], s3 offen sc1
  v_mul_f32 v81, v81, v37
  v_mul_f32 v82, v82, v38
  v_mul_f32 v83, v83, v39
  s_waitcnt lgkmcnt(6)
  v_mfma_f32_32x32x16_bf16 v[48:63], v[200:203], v[24:27], v[48:63]
  ds_read_b64_tr_b16 v[24:25], v3 offset:12288
  ds_read_b64_tr_b16 v[26:27], v3 offset:12800
  global_load_dword v5, v6, s[34:35] offset:2048 sc1
  v_exp_f32 v80, v80
  s_waitcnt lgkmcnt(6)
  v_mfma_f32_32x32x16_bf16 v[48:63], v[204:207], v[28:31], v[48:63]
  s_waitcnt vmcnt(13)
  s_barrier
  ds_read_b64_tr_b16 v[28:29], v3 offset:14336
  ds_read_b64_tr_b16 v[30:31], v3 offset:14848
  v_exp_f32 v81, v81
  v_exp_f32 v82, v82
  s_waitcnt lgkmcnt(6)
  v_mfma_f32_32x32x16_bf16 v[48:63], v[208:211], v[16:19], v[48:63]
  ds_read_b64_tr_b16 v[16:17], v3 offset:16384
  ds_read_b64_tr_b16 v[18:19], v3 offset:16896
  s_add_u32 s3, s63, 163840
  buffer_load_dwordx4 v[136:139], v4, s[40:43], s3 offen sc1
  v_exp_f32 v83, v83
  s_waitcnt lgkmcnt(6)
  v_mfma_f32_32x32x16_bf16 v[48:63], v[212:215], v[20:23], v[48:63]
  ds_read_b64_tr_b16 v[20:21], v3 offset:18432
  ds_read_b64_tr_b16 v[22:23], v3 offset:18944
  v_mul_f32 v44, v44, v36
  v_mul_f32 v45, v45, v37
  s_waitcnt lgkmcnt(6)
  v_mfma_f32_32x32x16_bf16 v[48:63], v[216:219], v[24:27], v[48:63]
  ds_read_b64_tr_b16 v[24:25], v3 offset:20480
  ds_read_b64_tr_b16 v[26:27], v3 offset:20992
  s_add_u32 s3, s63, 164864
  buffer_load_dwordx4 v[140:143], v4, s[40:43], s3 offen sc1
  v_mul_f32 v46, v46, v38
  v_mul_f32 v47, v47, v39
  v_fma_f32 v80, v80, v11, v11
  s_waitcnt lgkmcnt(6)
  v_mfma_f32_32x32x16_bf16 v[48:63], v[220:223], v[28:31], v[48:63]
  ds_read_b64_tr_b16 v[28:29], v3 offset:22528
  ds_read_b64_tr_b16 v[30:31], v3 offset:23040
  v_fma_f32 v81, v81, v11, v11
  v_fma_f32 v82, v82, v11, v11
  s_waitcnt lgkmcnt(6)
  v_mfma_f32_32x32x16_bf16 v[48:63], v[224:227], v[16:19], v[48:63]
  ds_read_b64_tr_b16 v[16:17], v3 offset:24576
  ds_read_b64_tr_b16 v[18:19], v3 offset:25088
  s_add_u32 s3, s63, 165888
  buffer_load_dwordx4 v[144:147], v4, s[40:43], s3 offen sc1
  v_fma_f32 v83, v83, v11, v11
  v_rcp_f32 v80, v80
  s_waitcnt lgkmcnt(6)
  v_mfma_f32_32x32x16_bf16 v[48:63], v[228:231], v[20:23], v[48:63]
  ds_read_b64_tr_b16 v[20:21], v3 offset:26624
  ds_read_b64_tr_b16 v[22:23], v3 offset:27136
  v_rcp_f32 v81, v81
  s_waitcnt lgkmcnt(6)
  v_mfma_f32_32x32x16_bf16 v[48:63], v[232:235], v[24:27], v[48:63]
  ds_read_b64_tr_b16 v[24:25], v3 offset:28672
  ds_read_b64_tr_b16 v[26:27], v3 offset:29184
  s_add_u32 s3, s63, 166912
  buffer_load_dwordx4 v[148:151], v4, s[40:43], s3 offen sc1
  v_rcp_f32 v82, v82
  v_rcp_f32 v83, v83
  s_waitcnt lgkmcnt(6)
  v_mfma_f32_32x32x16_bf16 v[48:63], v[236:239], v[28:31], v[48:63]
  s_cmp_lg_u32 s36, 0
  s_cbranch_scc1 L_ow_71
  s_waitcnt vmcnt(10)
  v_cmp_gt_u32 vcc, 27, v8
  s_nop 0
  s_and_b32 vcc_lo, vcc_lo, 0x1
  s_cbranch_scc0 L_polld_73
L_poll_72:
  s_sleep 2
  v_mov_b32 v8, 0
  s_mov_b64 exec, 0x1
  global_atomic_add v8, v65, v8, s[34:35] offset:0 sc0 sc1
  s_mov_b64 exec, -1
  s_waitcnt vmcnt(0)
  v_cmp_gt_u32 vcc, 27, v8
  s_nop 0
  s_and_b32 vcc_lo, vcc_lo, 0x1
  s_cbranch_scc0 L_polld_73
  s_add_u32 s79, s79, 1
  s_cmp_lt_u32 s79, 400000
  s_cbranch_scc1 L_poll_72
L_polld_73:
L_ow_71:
  s_waitcnt vmcnt(8)
  s_barrier
  ds_read_b64_tr_b16 v[28:29], v3 offset:30720
  ds_read_b64_tr_b16 v[30:31], v3 offset:31232
  v_mul_f32 v44, v44, v80
  s_waitcnt lgkmcnt(6)
  v_mfma_f32_32x32x16_bf16 v[48:63], v[240:243], v[16:19], v[48:63]
  s_add_u32 s3, s63, 167936
  buffer_load_dwordx4 v[152:155], v4, s[40:43], s3 offen sc1
  v_mul_f32 v45, v45, v81
  v_mul_f32 v46, v46, v82
  v_mul_f32 v47, v47, v83
  s_waitcnt lgkmcnt(4)
  v_mfma_f32_32x32x16_bf16 v[48:63], v[244:247], v[20:23], v[48:63]
  v_cvt_pk_bf16_f32 v90, v44, v45
  v_cvt_pk_bf16_f32 v91, v46, v47
  s_waitcnt lgkmcnt(2)
  v_mfma_f32_32x32x16_bf16 v[48:63], v[248:251], v[24:27], v[48:63]
  s_add_u32 s3, s65, 3538944
  buffer_store_dwordx4 v[88:91], v4, s[40:43], s3 offen sc1
  s_waitcnt lgkmcnt(0)
  v_mfma_f32_32x32x16_bf16 v[48:63], v[252:255], v[28:31], v[48:63]
  s_add_u32 s3, s83, 0
  buffer_load_dwordx4 v[16:19], v64, s[40:43], s3 offen offset:0 sc1
  buffer_load_dwordx4 v[20:23], v64, s[40:43], s3 offen offset:256 sc1
  s_add_u32 s3, s83, 16384
  buffer_load_dwordx4 v[24:27], v64, s[40:43], s3 offen offset:0 sc1
  buffer_load_dwordx4 v[28:31], v64, s[40:43], s3 offen offset:256 sc1
  v_add_u32 v76, s64, v4
  v_add_u32 v77, s60, v4
  v_add_u32 v78, s78, v4
  ds_read_b128 v[196:199], v76 offset:0
  ds_read_b128 v[200:203], v76 offset:1024
  ds_read_b128 v[204:207], v76 offset:2048
  ds_read_b128 v[208:211], v76 offset:3072
  ds_read_b128 v[212:215], v76 offset:4096
  ds_read_b128 v[216:219], v77 offset:0
  ds_read_b128 v[220:223], v77 offset:1024
  ds_read_b128 v[224:227], v77 offset:2048
  ds_read_b128 v[228:231], v77 offset:3072
  ds_read_b128 v[232:235], v78
  s_setprio 2
  s_waitcnt vmcnt(10)
  v_cmp_gt_u32 vcc, 0x10000, v5
  s_nop 0
  s_cbranch_vccz L_polld_75
L_poll_74:
  s_sleep 2
  global_load_dword v5, v6, s[34:35] offset:2048 sc1
  s_waitcnt vmcnt(0)
  v_cmp_gt_u32 vcc, 0x10000, v5
  s_nop 0
  s_cbranch_vccz L_polld_75
  s_add_u32 s79, s79, 1
  s_cmp_lt_u32 s79, 400000
  s_cbranch_scc1 L_poll_74
L_polld_75:
  s_mov_b32 s55, 0x01000100
  s_mov_b32 s56, 0x03020302
  v_perm_b32 v12, v5, v5, s55
  v_perm_b32 v13, v5, v5, s56
  v_xor_b32 v12, 0x80008000, v12
  v_and_b32 v11, 0xffff0000, v5
  v_rcp_f32 v10, v11
  v_mfma_f32_32x32x16_bf16 v[48:63], v[92:95], v[12:15], v[48:63]
  v_mul_f32 v11, v11, v11
  v_mul_f32 v9, v10, v10
  v_mul_f32 v10, 0xc0135761, v10
  v_mul_f32 v9, 0x3d372713, v9
  v_mul_f32 v9, v9, v10
  s_nop 6
  v_mul_f32 v32, v48, v48
  v_mul_f32 v33, v49, v49
  v_mul_f32 v34, v50, v50
  v_mul_f32 v35, v51, v51
  v_mul_f32 v36, v52, v52
  v_mul_f32 v37, v53, v53
  v_mul_f32 v38, v54, v54
  v_mul_f32 v39, v55, v55
  v_fma_f32 v32, v32, v9, v10
  v_fma_f32 v33, v33, v9, v10
  v_fma_f32 v34, v34, v9, v10
  v_fma_f32 v35, v35, v9, v10
  v_fma_f32 v36, v36, v9, v10
  v_fma_f32 v37, v37, v9, v10
  v_fma_f32 v38, v38, v9, v10
  v_fma_f32 v39, v39, v9, v10
  v_mul_f32 v32, v32, v48
  v_mul_f32 v33, v33, v49
  v_mul_f32 v34, v34, v50
  v_mul_f32 v35, v35, v51
  v_mul_f32 v36, v36, v52
  v_mul_f32 v37, v37, v53
  v_mul_f32 v38, v38, v54
  v_mul_f32 v39, v39, v55
  v_exp_f32 v32, v32
  v_exp_f32 v33, v33
  v_exp_f32 v34, v34
  v_exp_f32 v35, v35
  v_exp_f32 v36, v36
  v_exp_f32 v37, v37
  v_exp_f32 v38, v38
  v_exp_f32 v39, v39
  v_mul_f32 v56, v56, v48
  v_mul_f32 v57, v57, v49
  v_mul_f32 v58, v58, v50
  v_mul_f32 v59, v59, v51
  v_mul_f32 v60, v60, v52
  v_mul_f32 v61, v61, v53
  v_mul_f32 v62, v62, v54
  v_mul_f32 v63, v63, v55
  v_fma_f32 v32, v32, v11, v11
  v_fma_f32 v33, v33, v11, v11
  v_fma_f32 v34, v34, v11, v11
  v_fma_f32 v35, v35, v11, v11
  v_fma_f32 v36, v36, v11, v11
  v_fma_f32 v37, v37, v11, v11
  v_fma_f32 v38, v38, v11, v11
  v_fma_f32 v39, v39, v11, v11
  v_rcp_f32 v32, v32
  v_rcp_f32 v33, v33
  v_rcp_f32 v34, v34
  v_rcp_f32 v35, v35
  v_rcp_f32 v36, v36
  v_rcp_f32 v37, v37
  v_rcp_f32 v38, v38
  v_rcp_f32 v39, v39
  v_mul_f32 v56, v56, v32
  v_mul_f32 v57, v57, v33
  v_mul_f32 v58, v58, v34
  v_mul_f32 v59, v59, v35
  v_mul_f32 v60, v60, v36
  v_mul_f32 v61, v61, v37
  v_mul_f32 v62, v62, v38
  v_mul_f32 v63, v63, v39
  v_cvt_pk_bf16_f32 v88, v56, v57
  v_cvt_pk_bf16_f32 v89, v58, v59
  v_cvt_pk_bf16_f32 v90, v60, v61
  v_cvt_pk_bf16_f32 v91, v62, v63
  s_add_u32 s3, s65, 5308416
  buffer_store_dwordx4 v[88:91], v4, s[40:43], s3 offen sc1
  s_setprio 0
  s_add_u32 s3, s83, 32768
  buffer_load_dwordx4 v[236:239], v64, s[40:43], s3 offen offset:0 sc1
  buffer_load_dwordx4 v[240:243], v64, s[40:43], s3 offen offset:256 sc1
  s_add_u32 s3, s83, 49152
  buffer_load_dwordx4 v[244:247], v64, s[40:43], s3 offen offset:0 sc1
  buffer_load_dwordx4 v[248:251], v64, s[40:43], s3 offen offset:256 sc1
  ds_read_b64_tr_b16 v[92:93], v70 offset:0
  ds_read_b64_tr_b16 v[94:95], v71 offset:0
  ds_read_b64_tr_b16 v[90:91], v70 offset:5120
  ds_read_b64_tr_b16 v[6:7], v71 offset:5120
L_g2:
  s_waitcnt vmcnt(8) lgkmcnt(13)
  v_mfma_f32_16x16x32_bf16 v[32:35], v[196:199], v[16:19], 0
  s_add_u32 s3, s63, 204800
  buffer_load_dwordx4 v[156:159], v4, s[40:43], s3 offen sc1
  s_waitcnt lgkmcnt(12)
  v_mfma_f32_16x16x32_bf16 v[36:39], v[200:203], v[16:19], 0
  s_add_u32 s3, s63, 205824
  buffer_load_dwordx4 v[160:163], v4, s[40:43], s3 offen sc1
  s_waitcnt lgkmcnt(11)
  v_mfma_f32_16x16x32_bf16 v[40:43], v[204:207], v[16:19], 0
  s_add_u32 s3, s63, 206848
  buffer_load_dwordx4 v[164:167], v4, s[40:43], s3 offen sc1
  s_waitcnt lgkmcnt(10)
  v_mfma_f32_16x16x32_bf16 v[44:47], v[208:211], v[16:19], 0
  s_waitcnt lgkmcnt(9)
  v_mfma_f32_16x16x32_bf16 v[48:51], v[212:215], v[16:19], 0
  s_add_u32 s3, s83, 65536
  buffer_load_dwordx4 v[16:19], v64, s[40:43], s3 offen offset:0 sc1
  s_waitcnt vmcnt(11)
  v_mfma_f32_16x16x32_bf16 v[52:55], v[196:199], v[20:23], 0
  s_add_u32 s3, s63, 207872
  buffer_load_dwordx4 v[168:171], v4, s[40:43], s3 offen sc1
  v_mfma_f32_16x16x32_bf16 v[56:59], v[200:203], v[20:23], 0
  s_add_u32 s3, s63, 208896
  buffer_load_dwordx4 v[172:175], v4, s[40:43], s3 offen sc1
  v_mfma_f32_16x16x32_bf16 v[60:63], v[204:207], v[20:23], 0
  s_add_u32 s3, s76, 0
  buffer_load_dwordx4 v[176:179], v4, s[40:43], s3 offen sc1
  s_waitcnt vmcnt(11)
  v_mfma_f32_16x16x32_bf16 v[76:79], v[208:211], v[20:23], 0
  v_mfma_f32_16x16x32_bf16 v[80:83], v[212:215], v[20:23], 0
  s_add_u32 s3, s83, 65536
  buffer_load_dwordx4 v[20:23], v64, s[40:43], s3 offen offset:256 sc1
  s_cmp_lt_u32 s36, 4
  s_cbranch_scc1 L_pbs_76
  s_waitcnt lgkmcnt(0)
  s_barrier
L_pbs_76:
  s_waitcnt lgkmcnt(8)
  v_mfma_f32_16x16x32_bf16 v[32:35], v[216:219], v[24:27], v[32:35]
  s_add_u32 s3, s76, 1024
  buffer_load_dwordx4 v[180:183], v4, s[40:43], s3 offen sc1
  s_waitcnt lgkmcnt(7)
  v_mfma_f32_16x16x32_bf16 v[36:39], v[220:223], v[24:27], v[36:39]
  s_add_u32 s3, s76, 2048
  buffer_load_dwordx4 v[184:187], v4, s[40:43], s3 offen sc1
  s_waitcnt lgkmcnt(6)
  v_mfma_f32_16x16x32_bf16 v[40:43], v[224:227], v[24:27], v[40:43]
  s_add_u32 s3, s76, 3072
  buffer_load_dwordx4 v[188:191], v4, s[40:43], s3 offen sc1
  s_waitcnt lgkmcnt(5)
  v_mfma_f32_16x16x32_bf16 v[44:47], v[228:231], v[24:27], v[44:47]
  s_waitcnt lgkmcnt(4)
  v_mfma_f32_16x16x32_bf16 v[48:51], v[232:235], v[24:27], v[48:51]
  s_add_u32 s3, s83, 81920
  buffer_load_dwordx4 v[24:27], v64, s[40:43], s3 offen offset:0 sc1
  v_mfma_f32_16x16x32_bf16 v[52:55], v[216:219], v[28:31], v[52:55]
  s_add_u32 s3, s76, 4096
  buffer_load_dwordx4 v[192:195], v4, s[40:43], s3 offen sc1
  v_mfma_f32_16x16x32_bf16 v[56:59], v[220:223], v[28:31], v[56:59]
  v_mfma_f32_16x16x32_bf16 v[60:63], v[224:227], v[28:31], v[60:63]
  v_mfma_f32_16x16x32_bf16 v[76:79], v[228:231], v[28:31], v[76:79]
  v_mfma_f32_16x16x32_bf16 v[80:83], v[232:235], v[28:31], v[80:83]
  s_add_u32 s3, s83, 81920
  buffer_load_dwordx4 v[28:31], v64, s[40:43], s3 offen offset:256 sc1
  s_waitcnt vmcnt(17)
  v_mfma_f32_16x16x32_bf16 v[32:35], v[96:99], v[236:239], v[32:35]
  v_mfma_f32_16x16x32_bf16 v[36:39], v[100:103], v[236:239], v[36:39]
  v_mfma_f32_16x16x32_bf16 v[40:43], v[104:107], v[236:239], v[40:43]
  v_mfma_f32_16x16x32_bf16 v[44:47], v[108:111], v[236:239], v[44:47]
  v_mfma_f32_16x16x32_bf16 v[48:51], v[112:115], v[236:239], v[48:51]
  s_add_u32 s3, s77, 0
  buffer_load_dwordx4 v[236:239], v64, s[40:43], s3 offen offset:0 sc1
  s_waitcnt vmcnt(17)
  v_mfma_f32_16x16x32_bf16 v[52:55], v[96:99], v[240:243], v[52:55]
  v_mfma_f32_16x16x32_bf16 v[56:59], v[100:103], v[240:243], v[56:59]
  v_mfma_f32_16x16x32_bf16 v[60:63], v[104:107], v[240:243], v[60:63]
  v_mfma_f32_16x16x32_bf16 v[76:79], v[108:111], v[240:243], v[76:79]
  v_mfma_f32_16x16x32_bf16 v[80:83], v[112:115], v[240:243], v[80:83]
  s_add_u32 s3, s77, 0
  buffer_load_dwordx4 v[240:243], v64, s[40:43], s3 offen offset:256 sc1
  s_waitcnt vmcnt(17)
  v_mfma_f32_16x16x32_bf16 v[32:35], v[116:119], v[244:247], v[32:35]
  v_mfma_f32_16x16x32_bf16 v[36:39], v[120:123], v[244:247], v[36:39]
  v_mfma_f32_16x16x32_bf16 v[40:43], v[124:127], v[244:247], v[40:43]
  v_mfma_f32_16x16x32_bf16 v[44:47], v[128:131], v[244:247], v[44:47]
  v_mfma_f32_16x16x32_bf16 v[48:51], v[132:135], v[244:247], v[48:51]
  s_waitcnt vmcnt(16)
  v_mfma_f32_16x16x32_bf16 v[52:55], v[116:119], v[248:251], v[52:55]
  v_mfma_f32_16x16x32_bf16 v[56:59], v[120:123], v[248:251], v[56:59]
  v_mfma_f32_16x16x32_bf16 v[60:63], v[124:127], v[248:251], v[60:63]
  v_mfma_f32_16x16x32_bf16 v[76:79], v[128:131], v[248:251], v[76:79]
  v_mfma_f32_16x16x32_bf16 v[80:83], v[132:135], v[248:251], v[80:83]
  s_cmp_ge_u32 s36, 4
  s_cbranch_scc1 L_pbs_77
  s_waitcnt lgkmcnt(0)
  s_barrier
  s_cmp_lt_u32 s2, 40
  s_cbranch_scc1 L_hp_78
  s_cmp_lg_u32 s36, 0
  s_cbranch_scc1 L_ow_79
  s_add_u32 s55, s92, 16
  s_lshl_b32 s55, s55, 7
  s_add_u32 s55, s55, 86016
  v_mov_b32 v84, s55
  v_mov_b32 v85, 1
  s_mov_b64 exec, 1
  global_atomic_add v84, v85, s[34:35] sc1
  s_mov_b64 exec, -1
L_ow_79:
  s_cmp_lg_u32 s36, 0
  s_cbranch_scc1 L_ow_80
  s_add_u32 s55, s92, 24
  s_lshl_b32 s55, s55, 7
  s_add_u32 s55, s55, 86016
  v_mov_b32 v84, s55
  v_mov_b32 v85, 1
  s_mov_b64 exec, 1
  global_atomic_add v84, v85, s[34:35] sc1
  s_mov_b64 exec, -1
L_ow_80:
L_hp_78:
L_pbs_77:
  s_waitcnt vmcnt(12)
  v_mfma_f32_16x16x32_bf16 v[32:35], v[136:139], v[16:19], v[32:35]
  v_mfma_f32_16x16x32_bf16 v[36:39], v[140:143], v[16:19], v[36:39]
  v_mfma_f32_16x16x32_bf16 v[40:43], v[144:147], v[16:19], v[40:43]
  v_mfma_f32_16x16x32_bf16 v[44:47], v[148:151], v[16:19], v[44:47]
  v_mfma_f32_16x16x32_bf16 v[48:51], v[152:155], v[16:19], v[48:51]
  s_waitcnt vmcnt(8)
  v_mfma_f32_16x16x32_bf16 v[52:55], v[136:139], v[20:23], v[52:55]
  v_mfma_f32_16x16x32_bf16 v[56:59], v[140:143], v[20:23], v[56:59]
  v_mfma_f32_16x16x32_bf16 v[60:63], v[144:147], v[20:23], v[60:63]
  v_mfma_f32_16x16x32_bf16 v[76:79], v[148:151], v[20:23], v[76:79]
  v_mfma_f32_16x16x32_bf16 v[80:83], v[152:155], v[20:23], v[80:83]
  s_waitcnt vmcnt(4)
  v_mfma_f32_16x16x32_bf16 v[32:35], v[156:159], v[24:27], v[32:35]
  v_mfma_f32_16x16x32_bf16 v[36:39], v[160:163], v[24:27], v[36:39]
  v_mfma_f32_16x16x32_bf16 v[40:43], v[164:167], v[24:27], v[40:43]
  v_mfma_f32_16x16x32_bf16 v[44:47], v[168:171], v[24:27], v[44:47]
  v_mfma_f32_16x16x32_bf16 v[48:51], v[172:175], v[24:27], v[48:51]
  s_waitcnt vmcnt(2)
  v_mfma_f32_16x16x32_bf16 v[52:55], v[156:159], v[28:31], v[52:55]
  v_mfma_f32_16x16x32_bf16 v[56:59], v[160:163], v[28:31], v[56:59]
  v_mfma_f32_16x16x32_bf16 v[60:63], v[164:167], v[28:31], v[60:63]
  v_mfma_f32_16x16x32_bf16 v[76:79], v[168:171], v[28:31], v[76:79]
  v_mfma_f32_16x16x32_bf16 v[80:83], v[172:175], v[28:31], v[80:83]
  global_load_dwordx4 v[8:11], v72, s[34:35] sc1
  global_load_dwordx4 v[12:15], v73, s[34:35] sc1
  s_waitcnt vmcnt(3)
  v_mfma_f32_16x16x32_bf16 v[32:35], v[176:179], v[236:239], v[32:35]
  v_mfma_f32_16x16x32_bf16 v[36:39], v[180:183], v[236:239], v[36:39]
  v_mfma_f32_16x16x32_bf16 v[40:43], v[184:187], v[236:239], v[40:43]
  v_mfma_f32_16x16x32_bf16 v[44:47], v[188:191], v[236:239], v[44:47]
  v_mfma_f32_16x16x32_bf16 v[48:51], v[192:195], v[236:239], v[48:51]
  s_waitcnt vmcnt(2)
  v_mfma_f32_16x16x32_bf16 v[52:55], v[176:179], v[240:243], v[52:55]
  v_mfma_f32_16x16x32_bf16 v[56:59], v[180:183], v[240:243], v[56:59]
  v_mfma_f32_16x16x32_bf16 v[60:63], v[184:187], v[240:243], v[60:63]
  v_mfma_f32_16x16x32_bf16 v[76:79], v[188:191], v[240:243], v[76:79]
  v_mfma_f32_16x16x32_bf16 v[80:83], v[192:195], v[240:243], v[80:83]
  s_cmp_lg_u32 s36, 0
  s_cbranch_scc1 L_ow_81
  v_mov_b32 v3, 0
  s_mov_b64 exec, 0x1
  global_atomic_add v3, v65, v3, s[34:35] offset:2048 sc0 sc1
  s_mov_b64 exec, -1
L_ow_81:
  ds_write_b128 v66, v[32:35] offset:0
  ds_write_b128 v66, v[36:39] offset:8192
  ds_write_b128 v66, v[40:43] offset:16384
  ds_write_b128 v66, v[44:47] offset:24576
  ds_write_b128 v66, v[48:51] offset:32768
  ds_write_b128 v66, v[52:55] offset:40960
  ds_write_b128 v66, v[56:59] offset:49152
  ds_write_b128 v66, v[60:63] offset:57344
  ds_write_b128 v67, v[76:79] offset:0
  ds_write_b128 v67, v[80:83] offset:8192
  s_cmp_lg_u32 s36, 0
  s_cbranch_scc1 L_ow_82
  s_waitcnt vmcnt(0)
  v_cmp_gt_u32 vcc, 27, v3
  s_nop 0
  s_and_b32 vcc_lo, vcc_lo, 0x1
  s_cbranch_scc0 L_polld_84
L_poll_83:
  s_sleep 4
  v_mov_b32 v3, 0
  s_mov_b64 exec, 0x1
  global_atomic_add v3, v65, v3, s[34:35] offset:2048 sc0 sc1
  s_mov_b64 exec, -1
  s_waitcnt vmcnt(0)
  v_cmp_gt_u32 vcc, 27, v3
  s_nop 0
  s_and_b32 vcc_lo, vcc_lo, 0x1
  s_cbranch_scc0 L_polld_84
  s_add_u32 s79, s79, 1
  s_cmp_lt_u32 s79, 400000
  s_cbranch_scc1 L_poll_83
L_polld_84:
L_ow_82:
  v_add_u32 v66, 81920, v66
  v_add_u32 v67, 81920, v67
  s_waitcnt lgkmcnt(0)
  s_barrier
  s_add_u32 s3, s83, 3538944
  buffer_load_dwordx4 v[244:247], v64, s[40:43], s3 offen offset:0 sc1
  buffer_load_dwordx4 v[248:251], v64, s[40:43], s3 offen offset:256 sc1
  s_add_u32 s3, s83, 3555328
  buffer_load_dwordx4 v[16:19], v64, s[40:43], s3 offen offset:0 sc1
  buffer_load_dwordx4 v[20:23], v64, s[40:43], s3 offen offset:256 sc1
  ds_read_b128 v[32:35], v68 offset:0
  ds_read_b128 v[36:39], v68 offset:1024
  ds_read_b128 v[40:43], v68 offset:2048
  ds_read_b128 v[44:47], v68 offset:3072
  ds_read_b128 v[48:51], v69 offset:0
  ds_read_b128 v[52:55], v69 offset:1024
  ds_read_b128 v[56:59], v69 offset:2048
  ds_read_b128 v[60:63], v69 offset:3072
  s_add_u32 s3, s83, 3571712
  buffer_load_dwordx4 v[24:27], v64, s[40:43], s3 offen offset:0 sc1
  buffer_load_dwordx4 v[28:31], v64, s[40:43], s3 offen offset:256 sc1
  s_waitcnt lgkmcnt(6)
  v_pk_add_f32 v[32:33], v[32:33], v[36:37]
  v_pk_add_f32 v[34:35], v[34:35], v[38:39]
  s_waitcnt lgkmcnt(4)
  v_pk_add_f32 v[40:41], v[40:41], v[44:45]
  v_pk_add_f32 v[42:43], v[42:43], v[46:47]
  v_pk_add_f32 v[32:33], v[32:33], v[40:41]
  v_pk_add_f32 v[34:35], v[34:35], v[42:43]
  s_waitcnt lgkmcnt(2)
  v_pk_add_f32 v[48:49], v[48:49], v[52:53]
  v_pk_add_f32 v[50:51], v[50:51], v[54:55]
  s_waitcnt lgkmcnt(0)
  v_pk_add_f32 v[56:57], v[56:57], v[60:61]
  v_pk_add_f32 v[58:59], v[58:59], v[62:63]
  v_pk_add_f32 v[48:49], v[48:49], v[56:57]
  v_pk_add_f32 v[50:51], v[50:51], v[58:59]
  ds_read_b128 v[76:79], v68 offset:4096
  ds_read_b128 v[36:39], v68 offset:5120
  ds_read_b128 v[40:43], v68 offset:6144
  ds_read_b128 v[44:47], v68 offset:7168
  ds_read_b128 v[252:255], v69 offset:4096
  ds_read_b128 v[52:55], v69 offset:5120
  ds_read_b128 v[56:59], v69 offset:6144
  ds_read_b128 v[60:63], v69 offset:7168
  s_add_u32 s3, s83, 3588096
  buffer_load_dwordx4 v[236:239], v64, s[40:43], s3 offen offset:0 sc1
  buffer_load_dwordx4 v[240:243], v64, s[40:43], s3 offen offset:256 sc1
  s_waitcnt lgkmcnt(6)
  v_pk_add_f32 v[76:77], v[76:77], v[36:37]
  v_pk_add_f32 v[78:79], v[78:79], v[38:39]
  s_waitcnt lgkmcnt(4)
  v_pk_add_f32 v[40:41], v[40:41], v[44:45]
  v_pk_add_f32 v[42:43], v[42:43], v[46:47]
  v_pk_add_f32 v[32:33], v[32:33], v[76:77]
  v_pk_add_f32 v[34:35], v[34:35], v[78:79]
  v_pk_add_f32 v[32:33], v[32:33], v[40:41]
  v_pk_add_f32 v[34:35], v[34:35], v[42:43]
  s_waitcnt vmcnt(9)
  v_and_b32 v8, 0xffff0000, v8
  v_lshlrev_b32 v36, 16, v92
  v_fmac_f32 v36, v32, v8
  v_and_b32 v9, 0xffff0000, v9
  v_and_b32 v37, 0xffff0000, v92
  v_fmac_f32 v37, v33, v9
  v_and_b32 v10, 0xffff0000, v10
  v_lshlrev_b32 v38, 16, v93
  v_fmac_f32 v38, v34, v10
  v_and_b32 v11, 0xffff0000, v11
  v_and_b32 v39, 0xffff0000, v93
  v_fmac_f32 v39, v35, v11
  v_cvt_pk_bf16_f32 v84, v36, v37
  v_cvt_pk_bf16_f32 v85, v38, v39
  global_store_dwordx2 v74, v[84:85], s[30:31]
  s_waitcnt lgkmcnt(2)
  v_pk_add_f32 v[252:253], v[252:253], v[52:53]
  v_pk_add_f32 v[254:255], v[254:255], v[54:55]
  s_waitcnt lgkmcnt(0)
  v_pk_add_f32 v[56:57], v[56:57], v[60:61]
  v_pk_add_f32 v[58:59], v[58:59], v[62:63]
  v_pk_add_f32 v[48:49], v[48:49], v[252:253]
  v_pk_add_f32 v[50:51], v[50:51], v[254:255]
  v_pk_add_f32 v[48:49], v[48:49], v[56:57]
  v_pk_add_f32 v[50:51], v[50:51], v[58:59]
  s_waitcnt vmcnt(9)
  v_and_b32 v12, 0xffff0000, v12
  v_lshlrev_b32 v52, 16, v94
  v_fmac_f32 v52, v48, v12
  v_and_b32 v13, 0xffff0000, v13
  v_and_b32 v53, 0xffff0000, v94
  v_fmac_f32 v53, v49, v13
  v_and_b32 v14, 0xffff0000, v14
  v_lshlrev_b32 v54, 16, v95
  v_fmac_f32 v54, v50, v14
  v_and_b32 v15, 0xffff0000, v15
  v_and_b32 v55, 0xffff0000, v95
  v_fmac_f32 v55, v51, v15
  v_cvt_pk_bf16_f32 v88, v52, v53
  v_cvt_pk_bf16_f32 v89, v54, v55
  s_mov_b64 exec, 0xffff
  global_store_dwordx2 v75, v[88:89], s[30:31]
  s_mov_b64 exec, -1
  s_setprio 0
  v_add_u32 v74, 1310720, v74
  v_add_u32 v75, 1310720, v75
  v_add_u32 v68, 81920, v68
  v_add_u32 v69, 81920, v69
  s_waitcnt vmcnt(9)
  v_mfma_f32_16x16x32_bf16 v[32:35], v[196:199], v[244:247], 0
  v_mfma_f32_16x16x32_bf16 v[36:39], v[200:203], v[244:247], 0
  v_mfma_f32_16x16x32_bf16 v[40:43], v[204:207], v[244:247], 0
  v_mfma_f32_16x16x32_bf16 v[44:47], v[208:211], v[244:247], 0
  v_mfma_f32_16x16x32_bf16 v[48:51], v[212:215], v[244:247], 0
  s_add_u32 s3, s83, 3604480
  buffer_load_dwordx4 v[244:247], v64, s[40:43], s3 offen offset:0 sc1
  s_waitcnt vmcnt(9)
  v_mfma_f32_16x16x32_bf16 v[52:55], v[196:199], v[248:251], 0
  v_mfma_f32_16x16x32_bf16 v[56:59], v[200:203], v[248:251], 0
  v_mfma_f32_16x16x32_bf16 v[60:63], v[204:207], v[248:251], 0
  v_mfma_f32_16x16x32_bf16 v[76:79], v[208:211], v[248:251], 0
  v_mfma_f32_16x16x32_bf16 v[80:83], v[212:215], v[248:251], 0
  s_add_u32 s3, s83, 3604480
  buffer_load_dwordx4 v[248:251], v64, s[40:43], s3 offen offset:256 sc1
  s_waitcnt vmcnt(9)
  v_mfma_f32_16x16x32_bf16 v[32:35], v[216:219], v[16:19], v[32:35]
  v_mfma_f32_16x16x32_bf16 v[36:39], v[220:223], v[16:19], v[36:39]
  v_mfma_f32_16x16x32_bf16 v[40:43], v[224:227], v[16:19], v[40:43]
  v_mfma_f32_16x16x32_bf16 v[44:47], v[228:231], v[16:19], v[44:47]
  v_mfma_f32_16x16x32_bf16 v[48:51], v[232:235], v[16:19], v[48:51]
  s_add_u32 s3, s83, 3620864
  buffer_load_dwordx4 v[16:19], v64, s[40:43], s3 offen offset:0 sc1
  s_waitcnt vmcnt(9)
  v_mfma_f32_16x16x32_bf16 v[52:55], v[216:219], v[20:23], v[52:55]
  v_mfma_f32_16x16x32_bf16 v[56:59], v[220:223], v[20:23], v[56:59]
  v_mfma_f32_16x16x32_bf16 v[60:63], v[224:227], v[20:23], v[60:63]
  v_mfma_f32_16x16x32_bf16 v[76:79], v[228:231], v[20:23], v[76:79]
  v_mfma_f32_16x16x32_bf16 v[80:83], v[232:235], v[20:23], v[80:83]
  s_add_u32 s3, s83, 3620864
  buffer_load_dwordx4 v[20:23], v64, s[40:43], s3 offen offset:256 sc1
  s_waitcnt vmcnt(9)
  v_mfma_f32_16x16x32_bf16 v[32:35], v[96:99], v[24:27], v[32:35]
  v_mfma_f32_16x16x32_bf16 v[36:39], v[100:103], v[24:27], v[36:39]
  v_mfma_f32_16x16x32_bf16 v[40:43], v[104:107], v[24:27], v[40:43]
  v_mfma_f32_16x16x32_bf16 v[44:47], v[108:111], v[24:27], v[44:47]
  v_mfma_f32_16x16x32_bf16 v[48:51], v[112:115], v[24:27], v[48:51]
  s_add_u32 s3, s77, 3538944
  buffer_load_dwordx4 v[24:27], v64, s[40:43], s3 offen offset:0 sc1
  s_waitcnt vmcnt(9)
  v_mfma_f32_16x16x32_bf16 v[52:55], v[96:99], v[28:31], v[52:55]
  v_mfma_f32_16x16x32_bf16 v[56:59], v[100:103], v[28:31], v[56:59]
  v_mfma_f32_16x16x32_bf16 v[60:63], v[104:107], v[28:31], v[60:63]
  v_mfma_f32_16x16x32_bf16 v[76:79], v[108:111], v[28:31], v[76:79]
  v_mfma_f32_16x16x32_bf16 v[80:83], v[112:115], v[28:31], v[80:83]
  s_add_u32 s3, s77, 3538944
  buffer_load_dwordx4 v[28:31], v64, s[40:43], s3 offen offset:256 sc1
  s_waitcnt vmcnt(9)
  v_mfma_f32_16x16x32_bf16 v[32:35], v[116:119], v[236:239], v[32:35]
  v_mfma_f32_16x16x32_bf16 v[36:39], v[120:123], v[236:239], v[36:39]
  v_mfma_f32_16x16x32_bf16 v[40:43], v[124:127], v[236:239], v[40:43]
  v_mfma_f32_16x16x32_bf16 v[44:47], v[128:131], v[236:239], v[44:47]
  v_mfma_f32_16x16x32_bf16 v[48:51], v[132:135], v[236:239], v[48:51]
  s_waitcnt vmcnt(8)
  v_mfma_f32_16x16x32_bf16 v[52:55], v[116:119], v[240:243], v[52:55]
  v_mfma_f32_16x16x32_bf16 v[56:59], v[120:123], v[240:243], v[56:59]
  v_mfma_f32_16x16x32_bf16 v[60:63], v[124:127], v[240:243], v[60:63]
  v_mfma_f32_16x16x32_bf16 v[76:79], v[128:131], v[240:243], v[76:79]
  v_mfma_f32_16x16x32_bf16 v[80:83], v[132:135], v[240:243], v[80:83]
  s_waitcnt vmcnt(5)
  v_mfma_f32_16x16x32_bf16 v[32:35], v[136:139], v[244:247], v[32:35]
  v_mfma_f32_16x16x32_bf16 v[36:39], v[140:143], v[244:247], v[36:39]
  v_mfma_f32_16x16x32_bf16 v[40:43], v[144:147], v[244:247], v[40:43]
  v_mfma_f32_16x16x32_bf16 v[44:47], v[148:151], v[244:247], v[44:47]
  v_mfma_f32_16x16x32_bf16 v[48:51], v[152:155], v[244:247], v[48:51]
  s_waitcnt vmcnt(4)
  v_mfma_f32_16x16x32_bf16 v[52:55], v[136:139], v[248:251], v[52:55]
  v_mfma_f32_16x16x32_bf16 v[56:59], v[140:143], v[248:251], v[56:59]
  v_mfma_f32_16x16x32_bf16 v[60:63], v[144:147], v[248:251], v[60:63]
  v_mfma_f32_16x16x32_bf16 v[76:79], v[148:151], v[248:251], v[76:79]
  v_mfma_f32_16x16x32_bf16 v[80:83], v[152:155], v[248:251], v[80:83]
  s_waitcnt vmcnt(3)
  v_mfma_f32_16x16x32_bf16 v[32:35], v[156:159], v[16:19], v[32:35]
  v_mfma_f32_16x16x32_bf16 v[36:39], v[160:163], v[16:19], v[36:39]
  v_mfma_f32_16x16x32_bf16 v[40:43], v[164:167], v[16:19], v[40:43]
  v_mfma_f32_16x16x32_bf16 v[44:47], v[168:171], v[16:19], v[44:47]
  v_mfma_f32_16x16x32_bf16 v[48:51], v[172:175], v[16:19], v[48:51]
  s_waitcnt vmcnt(2)
  v_mfma_f32_16x16x32_bf16 v[52:55], v[156:159], v[20:23], v[52:55]
  v_mfma_f32_16x16x32_bf16 v[56:59], v[160:163], v[20:23], v[56:59]
  v_mfma_f32_16x16x32_bf16 v[60:63], v[164:167], v[20:23], v[60:63]
  v_mfma_f32_16x16x32_bf16 v[76:79], v[168:171], v[20:23], v[76:79]
  v_mfma_f32_16x16x32_bf16 v[80:83], v[172:175], v[20:23], v[80:83]
  s_waitcnt vmcnt(1)
  v_mfma_f32_16x16x32_bf16 v[32:35], v[176:179], v[24:27], v[32:35]
  v_mfma_f32_16x16x32_bf16 v[36:39], v[180:183], v[24:27], v[36:39]
  v_mfma_f32_16x16x32_bf16 v[40:43], v[184:187], v[24:27], v[40:43]
  v_mfma_f32_16x16x32_bf16 v[44:47], v[188:191], v[24:27], v[44:47]
  v_mfma_f32_16x16x32_bf16 v[48:51], v[192:195], v[24:27], v[48:51]
  s_waitcnt vmcnt(0)
  v_mfma_f32_16x16x32_bf16 v[52:55], v[176:179], v[28:31], v[52:55]
  v_mfma_f32_16x16x32_bf16 v[56:59], v[180:183], v[28:31], v[56:59]
  v_mfma_f32_16x16x32_bf16 v[60:63], v[184:187], v[28:31], v[60:63]
  v_mfma_f32_16x16x32_bf16 v[76:79], v[188:191], v[28:31], v[76:79]
  v_mfma_f32_16x16x32_bf16 v[80:83], v[192:195], v[28:31], v[80:83]
  ds_write_b128 v66, v[32:35] offset:0
  ds_write_b128 v66, v[36:39] offset:8192
  ds_write_b128 v66, v[40:43] offset:16384
  ds_write_b128 v66, v[44:47] offset:24576
  ds_write_b128 v66, v[48:51] offset:32768
  ds_write_b128 v66, v[52:55] offset:40960
  ds_write_b128 v66, v[56:59] offset:49152
  ds_write_b128 v66, v[60:63] offset:57344
  ds_write_b128 v67, v[76:79] offset:0
  ds_write_b128 v67, v[80:83] offset:8192
  s_waitcnt lgkmcnt(0)
  s_barrier
  ds_read_b128 v[32:35], v68 offset:0
  ds_read_b128 v[36:39], v68 offset:1024
  ds_read_b128 v[40:43], v68 offset:2048
  ds_read_b128 v[44:47], v68 offset:3072
  ds_read_b128 v[48:51], v69 offset:0
  ds_read_b128 v[52:55], v69 offset:1024
  ds_read_b128 v[56:59], v69 offset:2048
  ds_read_b128 v[60:63], v69 offset:3072
  s_waitcnt lgkmcnt(6)
  v_pk_add_f32 v[32:33], v[32:33], v[36:37]
  v_pk_add_f32 v[34:35], v[34:35], v[38:39]
  s_waitcnt lgkmcnt(4)
  v_pk_add_f32 v[40:41], v[40:41], v[44:45]
  v_pk_add_f32 v[42:43], v[42:43], v[46:47]
  v_pk_add_f32 v[32:33], v[32:33], v[40:41]
  v_pk_add_f32 v[34:35], v[34:35], v[42:43]
  s_waitcnt lgkmcnt(2)
  v_pk_add_f32 v[48:49], v[48:49], v[52:53]
  v_pk_add_f32 v[50:51], v[50:51], v[54:55]
  s_waitcnt lgkmcnt(0)
  v_pk_add_f32 v[56:57], v[56:57], v[60:61]
  v_pk_add_f32 v[58:59], v[58:59], v[62:63]
  v_pk_add_f32 v[48:49], v[48:49], v[56:57]
  v_pk_add_f32 v[50:51], v[50:51], v[58:59]
  ds_read_b128 v[76:79], v68 offset:4096
  ds_read_b128 v[36:39], v68 offset:5120
  ds_read_b128 v[40:43], v68 offset:6144
  ds_read_b128 v[44:47], v68 offset:7168
  ds_read_b128 v[252:255], v69 offset:4096
  ds_read_b128 v[52:55], v69 offset:5120
  ds_read_b128 v[56:59], v69 offset:6144
  ds_read_b128 v[60:63], v69 offset:7168
  s_waitcnt lgkmcnt(6)
  v_pk_add_f32 v[76:77], v[76:77], v[36:37]
  v_pk_add_f32 v[78:79], v[78:79], v[38:39]
  s_waitcnt lgkmcnt(4)
  v_pk_add_f32 v[40:41], v[40:41], v[44:45]
  v_pk_add_f32 v[42:43], v[42:43], v[46:47]
  v_pk_add_f32 v[32:33], v[32:33], v[76:77]
  v_pk_add_f32 v[34:35], v[34:35], v[78:79]
  v_pk_add_f32 v[32:33], v[32:33], v[40:41]
  v_pk_add_f32 v[34:35], v[34:35], v[42:43]
  v_lshlrev_b32 v36, 16, v90
  v_fmac_f32 v36, v32, v8
  v_and_b32 v37, 0xffff0000, v90
  v_fmac_f32 v37, v33, v9
  v_lshlrev_b32 v38, 16, v91
  v_fmac_f32 v38, v34, v10
  v_and_b32 v39, 0xffff0000, v91
  v_fmac_f32 v39, v35, v11
  v_cvt_pk_bf16_f32 v84, v36, v37
  v_cvt_pk_bf16_f32 v85, v38, v39
  global_store_dwordx2 v74, v[84:85], s[30:31]
  s_waitcnt lgkmcnt(2)
  v_pk_add_f32 v[252:253], v[252:253], v[52:53]
  v_pk_add_f32 v[254:255], v[254:255], v[54:55]
  s_waitcnt lgkmcnt(0)
  v_pk_add_f32 v[56:57], v[56:57], v[60:61]
  v_pk_add_f32 v[58:59], v[58:59], v[62:63]
  v_pk_add_f32 v[48:49], v[48:49], v[252:253]
  v_pk_add_f32 v[50:51], v[50:51], v[254:255]
  v_pk_add_f32 v[48:49], v[48:49], v[56:57]
  v_pk_add_f32 v[50:51], v[50:51], v[58:59]
  v_lshlrev_b32 v52, 16, v6
  v_fmac_f32 v52, v48, v12
  v_and_b32 v53, 0xffff0000, v6
  v_fmac_f32 v53, v49, v13
  v_lshlrev_b32 v54, 16, v7
  v_fmac_f32 v54, v50, v14
  v_and_b32 v55, 0xffff0000, v7
  v_fmac_f32 v55, v51, v15
  v_cvt_pk_bf16_f32 v88, v52, v53
  v_cvt_pk_bf16_f32 v89, v54, v55
  s_mov_b64 exec, 0xffff
  global_store_dwordx2 v75, v[88:89], s[30:31]
  s_mov_b64 exec, -1
  s_setprio 0
L_fin:
  s_or_b32 s3, s2, s36
  s_cmp_lg_u32 s3, 0
  s_cbranch_scc1 L_nogen
  v_mov_b32 v8, 139264
  v_mov_b32 v9, s93
  s_mov_b64 exec, 1
  global_store_dword v8, v9, s[34:35] sc1
  s_mov_b64 exec, -1
L_nogen:
  s_endpgm
L_helper:
  s_mov_b32 s48, s24
  s_and_b32 s49, s25, 0xffff
  s_mov_b32 s50, 2211840
  s_mov_b32 s51, 0x20000
  s_cmp_lt_u32 s2, 14
  s_cselect_b32 s76, 2, 1
  s_mov_b32 s75, s2
  s_mul_i32 s72, s36, 5120
  s_mul_i32 s71, s75, 40960
  s_add_u32 s71, s71, s72
  s_add_u32 s72, s72, 8192
  v_lshlrev_b32 v21, 4, v0
  s_cmp_lt_u32 s36, 6
  s_cbranch_scc1 L_nomp_85
  s_cmp_ge_u32 s2, 240
  s_cbranch_scc1 L_nomp_85
  s_waitcnt vmcnt(10)
  v_lshlrev_b32 v76, 16, v216
  v_and_b32 v77, 0xffff0000, v216
  v_mul_f32 v68, v76, v140
  v_mul_f32 v69, v77, v140
  v_lshlrev_b32 v78, 16, v217
  v_and_b32 v79, 0xffff0000, v217
  v_mul_f32 v70, v78, v140
  v_mul_f32 v71, v79, v140
  v_lshlrev_b32 v76, 16, v218
  v_and_b32 v77, 0xffff0000, v218
  v_mul_f32 v72, v76, v140
  v_mul_f32 v73, v77, v140
  v_lshlrev_b32 v78, 16, v219
  v_and_b32 v79, 0xffff0000, v219
  v_mul_f32 v74, v78, v140
  v_mul_f32 v75, v79, v140
  s_waitcnt vmcnt(9)
  v_lshlrev_b32 v76, 16, v220
  v_and_b32 v77, 0xffff0000, v220
  v_fmac_f32 v68, v76, v141
  v_fmac_f32 v69, v77, v141
  v_lshlrev_b32 v78, 16, v221
  v_and_b32 v79, 0xffff0000, v221
  v_fmac_f32 v70, v78, v141
  v_fmac_f32 v71, v79, v141
  v_lshlrev_b32 v76, 16, v222
  v_and_b32 v77, 0xffff0000, v222
  v_fmac_f32 v72, v76, v141
  v_fmac_f32 v73, v77, v141
  v_lshlrev_b32 v78, 16, v223
  v_and_b32 v79, 0xffff0000, v223
  v_fmac_f32 v74, v78, v141
  v_fmac_f32 v75, v79, v141
  s_waitcnt vmcnt(8)
  v_lshlrev_b32 v76, 16, v224
  v_and_b32 v77, 0xffff0000, v224
  v_fmac_f32 v68, v76, v142
  v_fmac_f32 v69, v77, v142
  v_lshlrev_b32 v78, 16, v225
  v_and_b32 v79, 0xffff0000, v225
  v_fmac_f32 v70, v78, v142
  v_fmac_f32 v71, v79, v142
  v_lshlrev_b32 v76, 16, v226
  v_and_b32 v77, 0xffff0000, v226
  v_fmac_f32 v72, v76, v142
  v_fmac_f32 v73, v77, v142
  v_lshlrev_b32 v78, 16, v227
  v_and_b32 v79, 0xffff0000, v227
  v_fmac_f32 v74, v78, v142
  v_fmac_f32 v75, v79, v142
  s_waitcnt vmcnt(7)
  v_lshlrev_b32 v76, 16, v228
  v_and_b32 v77, 0xffff0000, v228
  v_fmac_f32 v68, v76, v143
  v_fmac_f32 v69, v77, v143
  v_lshlrev_b32 v78, 16, v229
  v_and_b32 v79, 0xffff0000, v229
  v_fmac_f32 v70, v78, v143
  v_fmac_f32 v71, v79, v143
  v_lshlrev_b32 v76, 16, v230
  v_and_b32 v77, 0xffff0000, v230
  v_fmac_f32 v72, v76, v143
  v_fmac_f32 v73, v77, v143
  v_lshlrev_b32 v78, 16, v231
  v_and_b32 v79, 0xffff0000, v231
  v_fmac_f32 v74, v78, v143
  v_fmac_f32 v75, v79, v143
  s_waitcnt vmcnt(6)
  v_lshlrev_b32 v76, 16, v232
  v_and_b32 v77, 0xffff0000, v232
  v_fmac_f32 v68, v76, v144
  v_fmac_f32 v69, v77, v144
  v_lshlrev_b32 v78, 16, v233
  v_and_b32 v79, 0xffff0000, v233
  v_fmac_f32 v70, v78, v144
  v_fmac_f32 v71, v79, v144
  v_lshlrev_b32 v76, 16, v234
  v_and_b32 v77, 0xffff0000, v234
  v_fmac_f32 v72, v76, v144
  v_fmac_f32 v73, v77, v144
  v_lshlrev_b32 v78, 16, v235
  v_and_b32 v79, 0xffff0000, v235
  v_fmac_f32 v74, v78, v144
  v_fmac_f32 v75, v79, v144
  s_waitcnt vmcnt(5)
  v_lshlrev_b32 v76, 16, v236
  v_and_b32 v77, 0xffff0000, v236
  v_fmac_f32 v68, v76, v145
  v_fmac_f32 v69, v77, v145
  v_lshlrev_b32 v78, 16, v237
  v_and_b32 v79, 0xffff0000, v237
  v_fmac_f32 v70, v78, v145
  v_fmac_f32 v71, v79, v145
  v_lshlrev_b32 v76, 16, v238
  v_and_b32 v77, 0xffff0000, v238
  v_fmac_f32 v72, v76, v145
  v_fmac_f32 v73, v77, v145
  v_lshlrev_b32 v78, 16, v239
  v_and_b32 v79, 0xffff0000, v239
  v_fmac_f32 v74, v78, v145
  v_fmac_f32 v75, v79, v145
  s_waitcnt vmcnt(4)
  v_lshlrev_b32 v76, 16, v240
  v_and_b32 v77, 0xffff0000, v240
  v_fmac_f32 v68, v76, v146
  v_fmac_f32 v69, v77, v146
  v_lshlrev_b32 v78, 16, v241
  v_and_b32 v79, 0xffff0000, v241
  v_fmac_f32 v70, v78, v146
  v_fmac_f32 v71, v79, v146
  v_lshlrev_b32 v76, 16, v242
  v_and_b32 v77, 0xffff0000, v242
  v_fmac_f32 v72, v76, v146
  v_fmac_f32 v73, v77, v146
  v_lshlrev_b32 v78, 16, v243
  v_and_b32 v79, 0xffff0000, v243
  v_fmac_f32 v74, v78, v146
  v_fmac_f32 v75, v79, v146
  s_waitcnt vmcnt(3)
  v_lshlrev_b32 v76, 16, v244
  v_and_b32 v77, 0xffff0000, v244
  v_fmac_f32 v68, v76, v147
  v_fmac_f32 v69, v77, v147
  v_lshlrev_b32 v78, 16, v245
  v_and_b32 v79, 0xffff0000, v245
  v_fmac_f32 v70, v78, v147
  v_fmac_f32 v71, v79, v147
  v_lshlrev_b32 v76, 16, v246
  v_and_b32 v77, 0xffff0000, v246
  v_fmac_f32 v72, v76, v147
  v_fmac_f32 v73, v77, v147
  v_lshlrev_b32 v78, 16, v247
  v_and_b32 v79, 0xffff0000, v247
  v_fmac_f32 v74, v78, v147
  v_fmac_f32 v75, v79, v147
  s_waitcnt vmcnt(2)
  v_lshlrev_b32 v76, 16, v248
  v_and_b32 v77, 0xffff0000, v248
  v_fmac_f32 v68, v76, v148
  v_fmac_f32 v69, v77, v148
  v_lshlrev_b32 v78, 16, v249
  v_and_b32 v79, 0xffff0000, v249
  v_fmac_f32 v70, v78, v148
  v_fmac_f32 v71, v79, v148
  v_lshlrev_b32 v76, 16, v250
  v_and_b32 v77, 0xffff0000, v250
  v_fmac_f32 v72, v76, v148
  v_fmac_f32 v73, v77, v148
  v_lshlrev_b32 v78, 16, v251
  v_and_b32 v79, 0xffff0000, v251
  v_fmac_f32 v74, v78, v148
  v_fmac_f32 v75, v79, v148
  s_waitcnt vmcnt(1)
  v_lshlrev_b32 v76, 16, v252
  v_and_b32 v77, 0xffff0000, v252
  v_fmac_f32 v68, v76, v149
  v_fmac_f32 v69, v77, v149
  v_lshlrev_b32 v78, 16, v253
  v_and_b32 v79, 0xffff0000, v253
  v_fmac_f32 v70, v78, v149
  v_fmac_f32 v71, v79, v149
  v_lshlrev_b32 v76, 16, v254
  v_and_b32 v77, 0xffff0000, v254
  v_fmac_f32 v72, v76, v149
  v_fmac_f32 v73, v77, v149
  v_lshlrev_b32 v78, 16, v255
  v_and_b32 v79, 0xffff0000, v255
  v_fmac_f32 v74, v78, v149
  v_fmac_f32 v75, v79, v149
  v_permlane32_swap_b32 v68, v72
  v_permlane32_swap_b32 v69, v73
  v_permlane32_swap_b32 v70, v74
  v_permlane32_swap_b32 v71, v75
  v_add_f32 v68, v68, v72
  v_add_f32 v69, v69, v73
  v_add_f32 v70, v70, v74
  v_add_f32 v71, v71, v75
  s_nop 0
  v_permlane16_swap_b32 v68, v70
  v_permlane16_swap_b32 v69, v71
  v_add_f32 v68, v68, v70
  v_add_f32 v69, v69, v71
  v_lshrrev_b32 v76, 4, v0
  v_and_b32 v77, 7, v0
  v_lshlrev_b32 v76, 3, v76
  v_lshl_add_u32 v76, v77, 5, v76
  v_add_f32_dpp v68, v68, v68 row_ror:8 row_mask:0xf bank_mask:0xf
  v_add_f32_dpp v69, v69, v69 row_ror:8 row_mask:0xf bank_mask:0xf
  v_or_b32 v68, 1, v68
  v_or_b32 v69, 1, v69
  s_mov_b32 exec_lo, 0x00ff00ff
  s_mov_b32 exec_hi, 0x00ff00ff
  buffer_store_dwordx2 v[68:69], v76, s[40:43], s69 offen sc1
  s_mov_b64 exec, -1
L_nomp_85:
  s_barrier
  s_cmp_ge_u32 s76, 1
  s_cselect_b64 exec, -1, 0
  s_mov_b32 m0, s72
  s_add_u32 s72, s72, 1024
  buffer_load_dwordx4 v21, s[48:51], s71 offen nt lds
  s_mov_b64 exec, -1
  s_add_u32 s71, s71, 1024
  s_cmp_ge_u32 s76, 1
  s_cselect_b64 exec, -1, 0
  s_mov_b32 m0, s72
  s_add_u32 s72, s72, 1024
  buffer_load_dwordx4 v21, s[48:51], s71 offen nt lds
  s_mov_b64 exec, -1
  s_add_u32 s71, s71, 1024
  s_cmp_ge_u32 s76, 1
  s_cselect_b64 exec, -1, 0
  s_mov_b32 m0, s72
  s_add_u32 s72, s72, 1024
  buffer_load_dwordx4 v21, s[48:51], s71 offen nt lds
  s_mov_b64 exec, -1
  s_add_u32 s71, s71, 1024
  s_cmp_ge_u32 s76, 1
  s_cselect_b64 exec, -1, 0
  s_mov_b32 m0, s72
  s_add_u32 s72, s72, 1024
  buffer_load_dwordx4 v21, s[48:51], s71 offen nt lds
  s_mov_b64 exec, -1
  s_add_u32 s71, s71, 1024
  s_cmp_ge_u32 s76, 1
  s_cselect_b64 exec, -1, 0
  s_mov_b32 m0, s72
  s_add_u32 s72, s72, 36864
  buffer_load_dwordx4 v21, s[48:51], s71 offen nt lds
  s_mov_b64 exec, -1
  s_add_u32 s71, s71, 1634304
  s_cmp_ge_u32 s76, 2
  s_cselect_b64 exec, -1, 0
  s_mov_b32 m0, s72
  s_add_u32 s72, s72, 1024
  buffer_load_dwordx4 v21, s[48:51], s71 offen nt lds
  s_mov_b64 exec, -1
  s_add_u32 s71, s71, 1024
  s_cmp_ge_u32 s76, 2
  s_cselect_b64 exec, -1, 0
  s_mov_b32 m0, s72
  s_add_u32 s72, s72, 1024
  buffer_load_dwordx4 v21, s[48:51], s71 offen nt lds
  s_mov_b64 exec, -1
  s_add_u32 s71, s71, 1024
  s_cmp_ge_u32 s76, 2
  s_cselect_b64 exec, -1, 0
  s_mov_b32 m0, s72
  s_add_u32 s72, s72, 1024
  buffer_load_dwordx4 v21, s[48:51], s71 offen nt lds
  s_mov_b64 exec, -1
  s_add_u32 s71, s71, 1024
  s_cmp_ge_u32 s76, 2
  s_cselect_b64 exec, -1, 0
  s_mov_b32 m0, s72
  s_add_u32 s72, s72, 1024
  buffer_load_dwordx4 v21, s[48:51], s71 offen nt lds
  s_mov_b64 exec, -1
  s_add_u32 s71, s71, 1024
  s_cmp_ge_u32 s76, 2
  s_cselect_b64 exec, -1, 0
  s_mov_b32 m0, s72
  s_add_u32 s72, s72, 1024
  buffer_load_dwordx4 v21, s[48:51], s71 offen nt lds
  s_mov_b64 exec, -1
  s_add_u32 s71, s71, 1024
  s_cmp_lg_u32 s36, 0
  s_cbranch_scc1 L_ow_86
L_p1_87:
  global_load_dwordx4 v[58:61], v215, s[34:35] offset:0 sc1
  global_load_dwordx4 v[62:65], v215, s[34:35] offset:16 sc1
  s_waitcnt vmcnt(1)
  v_min3_u32 v66, v58, v59, v60
  v_max3_u32 v67, v58, v59, v60
  s_waitcnt vmcnt(0)
  v_min3_u32 v66, v66, v61, v62
  v_max3_u32 v67, v67, v61, v62
  v_min3_u32 v66, v66, v63, v64
  v_max3_u32 v67, v67, v63, v64
  v_min_u32 v66, v66, v65
  v_max_u32 v67, v67, v65
  v_xor_b32 v66, s93, v66
  v_xor_b32 v67, s93, v67
  v_or_b32 v66, v66, v67
  v_cmp_ne_u32 vcc, 0, v66
  s_nop 0
  s_cbranch_vccz L_p1d_88
  s_sleep 2
  s_add_u32 s79, s79, 1
  s_cmp_lt_u32 s79, 400000
  s_cbranch_scc1 L_p1_87
L_p1d_88:
  s_cmp_ge_u32 s2, 30
  s_cbranch_scc1 L_ow_86
  s_add_u32 s55, s2, 30
  s_lshl_b32 s56, s55, 11
  s_add_u32 s56, s56, 786432
  v_lshl_add_u32 v8, v0, 2, s56
L_fr_89:
  global_load_dword v32, v8, s[34:35] offset:0 sc1
  global_load_dword v33, v8, s[34:35] offset:256 sc1
  global_load_dword v34, v8, s[34:35] offset:512 sc1
  global_load_dword v35, v8, s[34:35] offset:768 sc1
  global_load_dword v36, v8, s[34:35] offset:1024 sc1
  global_load_dword v37, v8, s[34:35] offset:1280 sc1
  global_load_dword v38, v8, s[34:35] offset:1536 sc1
  global_load_dword v39, v8, s[34:35] offset:1792 sc1
  s_waitcnt vmcnt(5)
  v_min3_u32 v40, v32, v33, v34
  s_waitcnt vmcnt(3)
  v_min3_u32 v40, v40, v35, v36
  s_waitcnt vmcnt(1)
  v_min3_u32 v40, v40, v37, v38
  s_waitcnt vmcnt(0)
  v_min_u32 v40, v40, v39
  v_cmp_eq_u32 vcc, 0, v40
  s_nop 0
  s_cbranch_vccz L_fd_90
  s_sleep 2
  s_add_u32 s79, s79, 1
  s_cmp_lt_u32 s79, 400000
  s_cbranch_scc1 L_fr_89
L_fd_90:
  v_add_f32 v32, v32, v36
  v_add_f32 v33, v33, v37
  v_add_f32 v34, v34, v38
  v_add_f32 v35, v35, v39
  v_add_f32 v32, v32, v33
  v_add_f32 v34, v34, v35
  v_add_f32 v32, v32, v34
  v_cvt_pk_bf16_f32 v32, v32, v32
  v_and_b32 v32, 0xffff0000, v32
  v_or_b32 v32, 1, v32
  s_lshl_b32 s55, s55, 8
  s_add_u32 s55, s55, 147456
  v_lshlrev_b32 v8, 2, v0
  buffer_store_dword v32, v8, s[40:43], s55 offen sc1
L_ow_86:
  v_lshrrev_b32 v9, 5, v0
  v_lshlrev_b32 v9, 4, v9
  v_bfe_u32 v10, v0, 2, 3
  v_add_u32 v9, v9, v10
  v_mul_u32_u24 v9, 1280, v9
  v_and_b32 v10, 3, v0
  v_lshl_add_u32 v9, v10, 3, v9
  s_mul_i32 s56, s36, 160
  v_add_u32 v9, s56, v9
  s_mul_i32 s55, s36, 276480
  s_mul_i32 s56, s75, 5120
  s_add_u32 s55, s55, s56
  s_add_u32 s55, s55, 13631488
  s_waitcnt vmcnt(0)
  s_barrier
  s_cmp_eq_u32 s76, 0
  s_cbranch_scc1 L_wdd_92
L_wdl_91:
  ds_read_b64_tr_b16 v[32:33], v9 offset:8192
  ds_read_b64_tr_b16 v[34:35], v9 offset:18432
  ds_read_b64_tr_b16 v[36:37], v9 offset:8224
  ds_read_b64_tr_b16 v[38:39], v9 offset:18464
  ds_read_b64_tr_b16 v[40:41], v9 offset:8256
  ds_read_b64_tr_b16 v[42:43], v9 offset:18496
  ds_read_b64_tr_b16 v[44:45], v9 offset:8288
  ds_read_b64_tr_b16 v[46:47], v9 offset:18528
  ds_read_b64_tr_b16 v[48:49], v9 offset:8320
  ds_read_b64_tr_b16 v[50:51], v9 offset:18560
  s_add_u32 s56, s55, 4096
  s_waitcnt lgkmcnt(8)
  buffer_store_dwordx4 v[32:35], v21, s[40:43], s55 offen offset:0 sc1
  s_waitcnt lgkmcnt(6)
  buffer_store_dwordx4 v[36:39], v21, s[40:43], s55 offen offset:1024 sc1
  s_waitcnt lgkmcnt(4)
  buffer_store_dwordx4 v[40:43], v21, s[40:43], s55 offen offset:2048 sc1
  s_waitcnt lgkmcnt(2)
  buffer_store_dwordx4 v[44:47], v21, s[40:43], s55 offen offset:3072 sc1
  s_waitcnt lgkmcnt(0)
  buffer_store_dwordx4 v[48:51], v21, s[40:43], s56 offen offset:0 sc1
  s_add_u32 s55, s55, 204800
  v_add_u32 v9, 40960, v9
  s_sub_u32 s76, s76, 1
  s_cmp_lg_u32 s76, 0
  s_cbranch_scc1 L_wdl_91
L_wdd_92:
  s_waitcnt vmcnt(0)
  s_barrier
  s_cmp_lg_u32 s36, 0
  s_cbranch_scc1 L_ow_93
  s_and_b32 s55, s2, 3
  s_lshl_b32 s3, s55, 7
  s_add_u32 s3, s3, 81920
  v_mul_u32_u24 v16, 512, v0
  v_add_u32 v16, s3, v16
  v_mov_b32 v17, 1
  s_mov_b64 exec, 0xff
  global_atomic_add v16, v17, s[34:35] sc1
  s_mov_b64 exec, -1
L_ow_93:
  s_cmp_lg_u32 s36, 0
  s_cbranch_scc1 L_ow_97
  s_cmp_ge_u32 s2, 8
  s_cbranch_scc1 L_lateb_95
  s_and_b32 s3, s2, 7
  s_mul_i32 s3, s3, 3072
  s_add_u32 s3, s3, 32768
  v_min_u32 v16, 23, v0
  v_lshlrev_b32 v16, 7, v16
  v_add_u32 v16, s3, v16
  s_lshr_b32 s55, s2, 3
  s_mul_i32 s55, s55, 65536
  v_add_u32 v16, s55, v16
  v_mov_b32 v17, 0
  s_mov_b64 exec, 0xffffff
  global_atomic_add v17, v16, v17, s[34:35] offset:0 sc0 sc1
  s_mov_b64 exec, -1
  s_waitcnt vmcnt(0)
  v_cmp_gt_u32 vcc, 27, v17
  s_nop 0
  s_and_b32 vcc_lo, vcc_lo, 0xffffff
  s_cbranch_scc0 L_polld_99
L_poll_98:
  s_sleep 4
  v_mov_b32 v17, 0
  s_mov_b64 exec, 0xffffff
  global_atomic_add v17, v16, v17, s[34:35] offset:0 sc0 sc1
  s_mov_b64 exec, -1
  s_waitcnt vmcnt(0)
  v_cmp_gt_u32 vcc, 27, v17
  s_nop 0
  s_and_b32 vcc_lo, vcc_lo, 0xffffff
  s_cbranch_scc0 L_polld_99
  s_add_u32 s79, s79, 1
  s_cmp_lt_u32 s79, 400000
  s_cbranch_scc1 L_poll_98
L_polld_99:
  s_branch L_polled_96
L_lateb_95:
  s_and_b32 s3, s2, 7
  s_mul_i32 s3, s3, 3072
  s_add_u32 s3, s3, 57344
  v_min_u32 v16, 23, v0
  v_lshlrev_b32 v16, 7, v16
  v_add_u32 v16, s3, v16
  v_mov_b32 v17, 0
  s_mov_b64 exec, 0xffffff
  global_atomic_add v17, v16, v17, s[34:35] offset:0 sc0 sc1
  s_mov_b64 exec, -1
  s_waitcnt vmcnt(0)
  v_cmp_gt_u32 vcc, 9, v17
  s_nop 0
  s_and_b32 vcc_lo, vcc_lo, 0xffffff
  s_cbranch_scc0 L_polld_101
L_poll_100:
  s_sleep 4
  v_mov_b32 v17, 0
  s_mov_b64 exec, 0xffffff
  global_atomic_add v17, v16, v17, s[34:35] offset:0 sc0 sc1
  s_mov_b64 exec, -1
  s_waitcnt vmcnt(0)
  v_cmp_gt_u32 vcc, 9, v17
  s_nop 0
  s_and_b32 vcc_lo, vcc_lo, 0xffffff
  s_cbranch_scc0 L_polld_101
  s_add_u32 s79, s79, 1
  s_cmp_lt_u32 s79, 400000
  s_cbranch_scc1 L_poll_100
L_polld_101:
L_polled_96:
L_ow_97:
  s_barrier
  s_cmp_ge_u32 s2, 32
  s_cbranch_scc1 L_nostat_94
  v_lshrrev_b32 v8, 3, v0
  s_mul_i32 s55, s36, 80
  v_add_u32 v8, s55, v8
  v_mul_u32_u24 v8, 4224, v8
  v_and_b32 v10, 7, v0
  v_lshl_add_u32 v8, v10, 4, v8
  s_lshl_b32 s55, s2, 7
  s_add_u32 s55, s55, 7340032
  buffer_load_dwordx4 v[96:99], v8, s[40:43], s55 offen sc1
  s_add_u32 s55, s55, 33792
  buffer_load_dwordx4 v[100:103], v8, s[40:43], s55 offen sc1
  s_add_u32 s55, s55, 33792
  buffer_load_dwordx4 v[104:107], v8, s[40:43], s55 offen sc1
  s_add_u32 s55, s55, 33792
  buffer_load_dwordx4 v[108:111], v8, s[40:43], s55 offen sc1
  s_add_u32 s55, s55, 33792
  buffer_load_dwordx4 v[112:115], v8, s[40:43], s55 offen sc1
  s_add_u32 s55, s55, 33792
  buffer_load_dwordx4 v[116:119], v8, s[40:43], s55 offen sc1
  s_add_u32 s55, s55, 33792
  buffer_load_dwordx4 v[120:123], v8, s[40:43], s55 offen sc1
  s_add_u32 s55, s55, 33792
  buffer_load_dwordx4 v[124:127], v8, s[40:43], s55 offen sc1
  s_add_u32 s55, s55, 33792
  buffer_load_dwordx4 v[128:131], v8, s[40:43], s55 offen sc1
  s_add_u32 s55, s55, 33792
  buffer_load_dwordx4 v[132:135], v8, s[40:43], s55 offen sc1
  s_waitcnt vmcnt(9)
  v_lshlrev_b32 v32, 16, v96
  v_and_b32 v33, 0xffff0000, v96
  v_mul_f32 v40, v32, v32
  v_mul_f32 v41, v33, v33
  v_lshlrev_b32 v34, 16, v97
  v_and_b32 v35, 0xffff0000, v97
  v_mul_f32 v42, v34, v34
  v_mul_f32 v43, v35, v35
  v_lshlrev_b32 v36, 16, v98
  v_and_b32 v37, 0xffff0000, v98
  v_mul_f32 v44, v36, v36
  v_mul_f32 v45, v37, v37
  v_lshlrev_b32 v38, 16, v99
  v_and_b32 v39, 0xffff0000, v99
  v_mul_f32 v46, v38, v38
  v_mul_f32 v47, v39, v39
  s_waitcnt vmcnt(8)
  v_lshlrev_b32 v11, 16, v100
  v_and_b32 v12, 0xffff0000, v100
  v_add_f32 v32, v32, v11
  v_add_f32 v33, v33, v12
  v_fmac_f32 v40, v11, v11
  v_fmac_f32 v41, v12, v12
  v_lshlrev_b32 v11, 16, v101
  v_and_b32 v12, 0xffff0000, v101
  v_add_f32 v34, v34, v11
  v_add_f32 v35, v35, v12
  v_fmac_f32 v42, v11, v11
  v_fmac_f32 v43, v12, v12
  v_lshlrev_b32 v11, 16, v102
  v_and_b32 v12, 0xffff0000, v102
  v_add_f32 v36, v36, v11
  v_add_f32 v37, v37, v12
  v_fmac_f32 v44, v11, v11
  v_fmac_f32 v45, v12, v12
  v_lshlrev_b32 v11, 16, v103
  v_and_b32 v12, 0xffff0000, v103
  v_add_f32 v38, v38, v11
  v_add_f32 v39, v39, v12
  v_fmac_f32 v46, v11, v11
  v_fmac_f32 v47, v12, v12
  s_waitcnt vmcnt(7)
  v_lshlrev_b32 v11, 16, v104
  v_and_b32 v12, 0xffff0000, v104
  v_add_f32 v32, v32, v11
  v_add_f32 v33, v33, v12
  v_fmac_f32 v40, v11, v11
  v_fmac_f32 v41, v12, v12
  v_lshlrev_b32 v11, 16, v105
  v_and_b32 v12, 0xffff0000, v105
  v_add_f32 v34, v34, v11
  v_add_f32 v35, v35, v12
  v_fmac_f32 v42, v11, v11
  v_fmac_f32 v43, v12, v12
  v_lshlrev_b32 v11, 16, v106
  v_and_b32 v12, 0xffff0000, v106
  v_add_f32 v36, v36, v11
  v_add_f32 v37, v37, v12
  v_fmac_f32 v44, v11, v11
  v_fmac_f32 v45, v12, v12
  v_lshlrev_b32 v11, 16, v107
  v_and_b32 v12, 0xffff0000, v107
  v_add_f32 v38, v38, v11
  v_add_f32 v39, v39, v12
  v_fmac_f32 v46, v11, v11
  v_fmac_f32 v47, v12, v12
  s_waitcnt vmcnt(6)
  v_lshlrev_b32 v11, 16, v108
  v_and_b32 v12, 0xffff0000, v108
  v_add_f32 v32, v32, v11
  v_add_f32 v33, v33, v12
  v_fmac_f32 v40, v11, v11
  v_fmac_f32 v41, v12, v12
  v_lshlrev_b32 v11, 16, v109
  v_and_b32 v12, 0xffff0000, v109
  v_add_f32 v34, v34, v11
  v_add_f32 v35, v35, v12
  v_fmac_f32 v42, v11, v11
  v_fmac_f32 v43, v12, v12
  v_lshlrev_b32 v11, 16, v110
  v_and_b32 v12, 0xffff0000, v110
  v_add_f32 v36, v36, v11
  v_add_f32 v37, v37, v12
  v_fmac_f32 v44, v11, v11
  v_fmac_f32 v45, v12, v12
  v_lshlrev_b32 v11, 16, v111
  v_and_b32 v12, 0xffff0000, v111
  v_add_f32 v38, v38, v11
  v_add_f32 v39, v39, v12
  v_fmac_f32 v46, v11, v11
  v_fmac_f32 v47, v12, v12
  s_waitcnt vmcnt(5)
  v_lshlrev_b32 v11, 16, v112
  v_and_b32 v12, 0xffff0000, v112
  v_add_f32 v32, v32, v11
  v_add_f32 v33, v33, v12
  v_fmac_f32 v40, v11, v11
  v_fmac_f32 v41, v12, v12
  v_lshlrev_b32 v11, 16, v113
  v_and_b32 v12, 0xffff0000, v113
  v_add_f32 v34, v34, v11
  v_add_f32 v35, v35, v12
  v_fmac_f32 v42, v11, v11
  v_fmac_f32 v43, v12, v12
  v_lshlrev_b32 v11, 16, v114
  v_and_b32 v12, 0xffff0000, v114
  v_add_f32 v36, v36, v11
  v_add_f32 v37, v37, v12
  v_fmac_f32 v44, v11, v11
  v_fmac_f32 v45, v12, v12
  v_lshlrev_b32 v11, 16, v115
  v_and_b32 v12, 0xffff0000, v115
  v_add_f32 v38, v38, v11
  v_add_f32 v39, v39, v12
  v_fmac_f32 v46, v11, v11
  v_fmac_f32 v47, v12, v12
  s_waitcnt vmcnt(4)
  v_lshlrev_b32 v11, 16, v116
  v_and_b32 v12, 0xffff0000, v116
  v_add_f32 v32, v32, v11
  v_add_f32 v33, v33, v12
  v_fmac_f32 v40, v11, v11
  v_fmac_f32 v41, v12, v12
  v_lshlrev_b32 v11, 16, v117
  v_and_b32 v12, 0xffff0000, v117
  v_add_f32 v34, v34, v11
  v_add_f32 v35, v35, v12
  v_fmac_f32 v42, v11, v11
  v_fmac_f32 v43, v12, v12
  v_lshlrev_b32 v11, 16, v118
  v_and_b32 v12, 0xffff0000, v118
  v_add_f32 v36, v36, v11
  v_add_f32 v37, v37, v12
  v_fmac_f32 v44, v11, v11
  v_fmac_f32 v45, v12, v12
  v_lshlrev_b32 v11, 16, v119
  v_and_b32 v12, 0xffff0000, v119
  v_add_f32 v38, v38, v11
  v_add_f32 v39, v39, v12
  v_fmac_f32 v46, v11, v11
  v_fmac_f32 v47, v12, v12
  s_waitcnt vmcnt(3)
  v_lshlrev_b32 v11, 16, v120
  v_and_b32 v12, 0xffff0000, v120
  v_add_f32 v32, v32, v11
  v_add_f32 v33, v33, v12
  v_fmac_f32 v40, v11, v11
  v_fmac_f32 v41, v12, v12
  v_lshlrev_b32 v11, 16, v121
  v_and_b32 v12, 0xffff0000, v121
  v_add_f32 v34, v34, v11
  v_add_f32 v35, v35, v12
  v_fmac_f32 v42, v11, v11
  v_fmac_f32 v43, v12, v12
  v_lshlrev_b32 v11, 16, v122
  v_and_b32 v12, 0xffff0000, v122
  v_add_f32 v36, v36, v11
  v_add_f32 v37, v37, v12
  v_fmac_f32 v44, v11, v11
  v_fmac_f32 v45, v12, v12
  v_lshlrev_b32 v11, 16, v123
  v_and_b32 v12, 0xffff0000, v123
  v_add_f32 v38, v38, v11
  v_add_f32 v39, v39, v12
  v_fmac_f32 v46, v11, v11
  v_fmac_f32 v47, v12, v12
  s_waitcnt vmcnt(2)
  v_lshlrev_b32 v11, 16, v124
  v_and_b32 v12, 0xffff0000, v124
  v_add_f32 v32, v32, v11
  v_add_f32 v33, v33, v12
  v_fmac_f32 v40, v11, v11
  v_fmac_f32 v41, v12, v12
  v_lshlrev_b32 v11, 16, v125
  v_and_b32 v12, 0xffff0000, v125
  v_add_f32 v34, v34, v11
  v_add_f32 v35, v35, v12
  v_fmac_f32 v42, v11, v11
  v_fmac_f32 v43, v12, v12
  v_lshlrev_b32 v11, 16, v126
  v_and_b32 v12, 0xffff0000, v126
  v_add_f32 v36, v36, v11
  v_add_f32 v37, v37, v12
  v_fmac_f32 v44, v11, v11
  v_fmac_f32 v45, v12, v12
  v_lshlrev_b32 v11, 16, v127
  v_and_b32 v12, 0xffff0000, v127
  v_add_f32 v38, v38, v11
  v_add_f32 v39, v39, v12
  v_fmac_f32 v46, v11, v11
  v_fmac_f32 v47, v12, v12
  s_waitcnt vmcnt(1)
  v_lshlrev_b32 v11, 16, v128
  v_and_b32 v12, 0xffff0000, v128
  v_add_f32 v32, v32, v11
  v_add_f32 v33, v33, v12
  v_fmac_f32 v40, v11, v11
  v_fmac_f32 v41, v12, v12
  v_lshlrev_b32 v11, 16, v129
  v_and_b32 v12, 0xffff0000, v129
  v_add_f32 v34, v34, v11
  v_add_f32 v35, v35, v12
  v_fmac_f32 v42, v11, v11
  v_fmac_f32 v43, v12, v12
  v_lshlrev_b32 v11, 16, v130
  v_and_b32 v12, 0xffff0000, v130
  v_add_f32 v36, v36, v11
  v_add_f32 v37, v37, v12
  v_fmac_f32 v44, v11, v11
  v_fmac_f32 v45, v12, v12
  v_lshlrev_b32 v11, 16, v131
  v_and_b32 v12, 0xffff0000, v131
  v_add_f32 v38, v38, v11
  v_add_f32 v39, v39, v12
  v_fmac_f32 v46, v11, v11
  v_fmac_f32 v47, v12, v12
  s_waitcnt vmcnt(0)
  v_lshlrev_b32 v11, 16, v132
  v_and_b32 v12, 0xffff0000, v132
  v_add_f32 v32, v32, v11
  v_add_f32 v33, v33, v12
  v_fmac_f32 v40, v11, v11
  v_fmac_f32 v41, v12, v12
  v_lshlrev_b32 v11, 16, v133
  v_and_b32 v12, 0xffff0000, v133
  v_add_f32 v34, v34, v11
  v_add_f32 v35, v35, v12
  v_fmac_f32 v42, v11, v11
  v_fmac_f32 v43, v12, v12
  v_lshlrev_b32 v11, 16, v134
  v_and_b32 v12, 0xffff0000, v134
  v_add_f32 v36, v36, v11
  v_add_f32 v37, v37, v12
  v_fmac_f32 v44, v11, v11
  v_fmac_f32 v45, v12, v12
  v_lshlrev_b32 v11, 16, v135
  v_and_b32 v12, 0xffff0000, v135
  v_add_f32 v38, v38, v11
  v_add_f32 v39, v39, v12
  v_fmac_f32 v46, v11, v11
  v_fmac_f32 v47, v12, v12
  v_permlane32_swap_b32 v32, v40
  v_permlane32_swap_b32 v33, v41
  v_permlane32_swap_b32 v34, v42
  v_permlane32_swap_b32 v35, v43
  v_permlane32_swap_b32 v36, v44
  v_permlane32_swap_b32 v37, v45
  v_permlane32_swap_b32 v38, v46
  v_permlane32_swap_b32 v39, v47
  v_add_f32 v32, v32, v40
  v_add_f32 v33, v33, v41
  v_add_f32 v34, v34, v42
  v_add_f32 v35, v35, v43
  v_add_f32 v36, v36, v44
  v_add_f32 v37, v37, v45
  v_add_f32 v38, v38, v46
  v_add_f32 v39, v39, v47
  v_permlane16_swap_b32 v32, v36
  v_permlane16_swap_b32 v33, v37
  v_permlane16_swap_b32 v34, v38
  v_permlane16_swap_b32 v35, v39
  v_add_f32 v32, v32, v36
  v_add_f32 v33, v33, v37
  v_add_f32 v34, v34, v38
  v_add_f32 v35, v35, v39
  v_add_f32_dpp v32, v32, v32 row_ror:8 row_mask:0xf bank_mask:0xf
  v_add_f32_dpp v33, v33, v33 row_ror:8 row_mask:0xf bank_mask:0xf
  v_add_f32_dpp v34, v34, v34 row_ror:8 row_mask:0xf bank_mask:0xf
  v_add_f32_dpp v35, v35, v35 row_ror:8 row_mask:0xf bank_mask:0xf
  v_lshrrev_b32 v8, 4, v0
  v_mul_u32_u24 v8, 4, v8
  v_and_b32 v9, 7, v8
  v_lshrrev_b32 v8, 3, v8
  v_lshl_add_u32 v9, v8, 6, v9
  v_and_b32 v8, 7, v0
  v_lshl_add_u32 v9, v8, 3, v9
  s_mul_i32 s55, s36, 128
  v_add_u32 v9, s55, v9
  v_lshlrev_b32 v9, 2, v9
  s_mov_b32 exec_lo, 0x00ff00ff
  s_mov_b32 exec_hi, 0x00ff00ff
  ds_write_b128 v9, v[32:35] offset:0
  s_mov_b64 exec, -1
  s_waitcnt lgkmcnt(0)
  s_barrier
  s_cmp_lg_u32 s36, 0
  s_cbranch_scc1 L_ow_102
  v_lshlrev_b32 v8, 2, v0
  ds_read2st64_b32 v[32:33], v8 offset0:0 offset1:1
  ds_read2st64_b32 v[34:35], v8 offset0:2 offset1:3
  ds_read2st64_b32 v[36:37], v8 offset0:4 offset1:5
  ds_read2st64_b32 v[38:39], v8 offset0:6 offset1:7
  ds_read2st64_b32 v[40:41], v8 offset0:8 offset1:9
  ds_read2st64_b32 v[42:43], v8 offset0:10 offset1:11
  ds_read2st64_b32 v[44:45], v8 offset0:12 offset1:13
  ds_read2st64_b32 v[46:47], v8 offset0:14 offset1:15
  s_waitcnt lgkmcnt(6)
  v_add_f32 v32, v32, v34
  v_add_f32 v33, v33, v35
  s_waitcnt lgkmcnt(5)
  v_add_f32 v32, v32, v36
  v_add_f32 v33, v33, v37
  s_waitcnt lgkmcnt(4)
  v_add_f32 v32, v32, v38
  v_add_f32 v33, v33, v39
  s_waitcnt lgkmcnt(3)
  v_add_f32 v32, v32, v40
  v_add_f32 v33, v33, v41
  s_waitcnt lgkmcnt(2)
  v_add_f32 v32, v32, v42
  v_add_f32 v33, v33, v43
  s_waitcnt lgkmcnt(1)
  v_add_f32 v32, v32, v44
  v_add_f32 v33, v33, v45
  s_waitcnt lgkmcnt(0)
  v_add_f32 v32, v32, v46
  v_add_f32 v33, v33, v47
  v_mul_f32 v10, 0x3acccccd, v32
  v_mul_f32 v11, 0x3acccccd, v33
  v_fma_f32 v11, -v10, v10, v11
  v_max_f32 v11, 0, v11
  v_cvt_pk_bf16_f32 v11, v11, v11
  v_lshlrev_b32 v11, 16, v11
  v_add_f32 v11, 0x3727c5ac, v11
  v_cvt_pk_bf16_f32 v11, v11, v11
  v_lshlrev_b32 v11, 16, v11
  v_sqrt_f32 v11, v11
  s_nop 0
  v_cvt_pk_bf16_f32 v10, v10, v11
  s_lshl_b32 s55, s2, 8
  s_add_u32 s55, s55, 90112
  buffer_store_dword v10, v8, s[40:43], s55 offen sc1
L_ow_102:
  s_barrier
L_nostat_94:
  s_cmp_lg_u32 s36, 0
  s_cbranch_scc1 L_ow_103
  s_and_b32 s3, s2, 7
  s_mul_i32 s3, s3, 3072
  s_add_u32 s3, s3, 57344
  v_min_u32 v16, 23, v0
  v_lshlrev_b32 v16, 7, v16
  v_add_u32 v16, s3, v16
  v_mov_b32 v17, 0
  s_mov_b64 exec, 0xffffff
  global_atomic_add v17, v16, v17, s[34:35] offset:0 sc0 sc1
  s_mov_b64 exec, -1
  s_waitcnt vmcnt(0)
  v_cmp_gt_u32 vcc, 9, v17
  s_nop 0
  s_and_b32 vcc_lo, vcc_lo, 0xffffff
  s_cbranch_scc0 L_polld_105
L_poll_104:
  s_sleep 4
  v_mov_b32 v17, 0
  s_mov_b64 exec, 0xffffff
  global_atomic_add v17, v16, v17, s[34:35] offset:0 sc0 sc1
  s_mov_b64 exec, -1
  s_waitcnt vmcnt(0)
  v_cmp_gt_u32 vcc, 9, v17
  s_nop 0
  s_and_b32 vcc_lo, vcc_lo, 0xffffff
  s_cbranch_scc0 L_polld_105
  s_add_u32 s79, s79, 1
  s_cmp_lt_u32 s79, 400000
  s_cbranch_scc1 L_poll_104
L_polld_105:
  s_and_b32 s3, s2, 7
  s_mul_i32 s3, s3, 512
  s_add_u32 s3, s3, 81920
  v_min_u32 v16, 3, v0
  v_lshlrev_b32 v16, 7, v16
  v_add_u32 v16, s3, v16
  v_mov_b32 v17, 0
  s_mov_b64 exec, 0xf
  global_atomic_add v17, v16, v17, s[34:35] offset:0 sc0 sc1
  s_mov_b64 exec, -1
  s_waitcnt vmcnt(0)
  v_cmp_gt_u32 vcc, 10, v17
  s_nop 0
  s_and_b32 vcc_lo, vcc_lo, 0xf
  s_cbranch_scc0 L_polld_107
L_poll_106:
  s_sleep 2
  v_mov_b32 v17, 0
  s_mov_b64 exec, 0xf
  global_atomic_add v17, v16, v17, s[34:35] offset:0 sc0 sc1
  s_mov_b64 exec, -1
  s_waitcnt vmcnt(0)
  v_cmp_gt_u32 vcc, 10, v17
  s_nop 0
  s_and_b32 vcc_lo, vcc_lo, 0xf
  s_cbranch_scc0 L_polld_107
  s_add_u32 s79, s79, 1
  s_cmp_lt_u32 s79, 400000
  s_cbranch_scc1 L_poll_106
L_polld_107:
L_ow_103:
  s_barrier
  s_lshr_b32 s55, s2, 3
  s_and_b32 s61, s55, 7
  s_lshr_b32 s55, s55, 3
  s_and_b32 s90, s55, 1
  s_lshr_b32 s55, s55, 1
  s_lshl_b32 s55, s55, 3
  s_add_u32 s62, s55, s53
  s_mul_i32 s55, s36, 5120
  s_add_u32 s64, s55, 122880
  s_add_u32 s60, s55, 98304
  s_sub_u32 s56, s55, 20480
  s_cmp_ge_u32 s36, 4
  s_cselect_b32 s60, s56, s60
  s_add_u32 s78, s60, 4096
  s_cmp_eq_u32 s36, 7
  s_cmov_b32 s60, 118784
  s_cmov_b32 s78, 15360
  s_mul_i32 s63, s61, 276480
  s_add_u32 s63, s63, 13631488
  s_add_u32 s63, s63, s55
  v_lshlrev_b32 v4, 4, v0
  v_lshrrev_b32 v76, 5, v0
  v_lshlrev_b32 v64, 10, v76
  v_bfe_u32 v76, v0, 4, 1
  v_lshl_add_u32 v64, v76, 9, v64
  v_and_b32 v77, 15, v0
  v_lshl_add_u32 v64, v77, 4, v64
  s_lshl_b32 s55, s62, 1
  s_add_u32 s55, s55, s90
  s_mul_i32 s55, s55, 110592
  s_lshl_b32 s56, s36, 11
  s_add_u32 s55, s55, s56
  s_add_u32 s83, s55, 16777216
  s_add_u32 s76, s63, 245760
  s_add_u32 s77, s83, 98304
  s_cmp_ge_u32 s36, 6
  s_cmov_b32 s76, 0x2000000
  s_cmov_b32 s77, 0x2000000
  s_lshl_b32 s55, s62, 7
  s_add_u32 s55, s55, 86016
  v_mov_b32 v65, s55
  s_lshl_b32 s55, s36, 10
  s_add_u32 s55, s55, 0
  v_add_u32 v66, s55, v4
  v_add_u32 v67, 65536, v66
  s_lshl_b32 s55, s36, 13
  s_add_u32 s55, s55, 0
  v_add_u32 v68, s55, v4
  s_lshr_b32 s57, s36, 2
  s_and_b32 s58, s36, 3
  s_lshl_b32 s55, s57, 13
  s_lshl_b32 s56, s58, 8
  s_add_u32 s55, s55, s56
  s_add_u32 s55, s55, 65536
  v_lshl_add_u32 v69, v77, 4, s55
  s_cmp_ge_u32 s36, 5
  s_cselect_b32 s59, 1, 0
  s_mul_i32 s55, s59, 5
  s_sub_u32 s86, s36, s55
  s_add_u32 s57, s57, 3
  v_lshrrev_b32 v76, 2, v0
  v_lshlrev_b32 v70, 6, v76
  v_and_b32 v78, 3, v0
  v_lshl_add_u32 v70, v78, 3, v70
  v_and_b32 v71, 0xff, v70
  s_lshl_b32 s55, s86, 10
  s_lshl_b32 s56, s59, 5
  s_add_u32 s55, s55, s56
  s_add_u32 s55, s55, 16384
  v_add_u32 v70, s55, v70
  s_lshl_b32 s55, s57, 10
  s_lshl_b32 s56, s58, 8
  s_add_u32 s55, s55, s56
  s_add_u32 s55, s55, 16416
  v_add_u32 v71, s55, v71
  s_mul_i32 s87, s61, 80
  s_lshl_b32 s55, s86, 4
  s_add_u32 s55, s55, s87
  v_lshrrev_b32 v76, 4, v0
  v_lshl_add_u32 v72, v76, 2, s55
  s_lshl_b32 s55, s57, 4
  s_lshl_b32 s56, s58, 2
  s_add_u32 s55, s55, s56
  s_add_u32 s55, s55, s87
  v_mov_b32 v73, s55
  s_lshl_b32 s55, s90, 5
  s_lshl_b32 s56, s59, 4
  s_add_u32 s56, s56, s55
  s_add_u32 s55, s55, 16
  s_lshr_b32 s88, s62, 3
  s_lshl_b32 s88, s88, 9
  s_lshl_b32 s89, s53, 3
  s_add_u32 s88, s88, s89
  v_add_u32 v76, s56, v77
  v_and_b32 v78, 7, v76
  v_lshrrev_b32 v76, 3, v76
  v_lshl_add_u32 v76, v78, 6, v76
  v_add_u32 v76, s88, v76
  v_mul_u32_u24 v76, 1280, v76
  v_lshl_add_u32 v74, v72, 1, v76
  v_lshlrev_b32 v72, 2, v72
  v_add_u32 v72, 160256, v72
  v_add_u32 v76, s55, v77
  v_and_b32 v78, 7, v76
  v_lshrrev_b32 v76, 3, v76
  v_lshl_add_u32 v76, v78, 6, v76
  v_add_u32 v76, s88, v76
  v_mul_u32_u24 v76, 1280, v76
  v_lshl_add_u32 v75, v73, 1, v76
  v_lshlrev_b32 v73, 2, v73
  v_add_u32 v73, 160256, v73
  s_add_u32 s3, s63, 0
  buffer_load_dwordx4 v[196:199], v4, s[40:43], s3 offen sc1
  s_add_u32 s3, s63, 1024
  buffer_load_dwordx4 v[200:203], v4, s[40:43], s3 offen sc1
  s_add_u32 s3, s63, 2048
  buffer_load_dwordx4 v[204:207], v4, s[40:43], s3 offen sc1
  s_add_u32 s3, s63, 3072
  buffer_load_dwordx4 v[208:211], v4, s[40:43], s3 offen sc1
  s_add_u32 s3, s63, 4096
  buffer_load_dwordx4 v[212:215], v4, s[40:43], s3 offen sc1
  s_add_u32 s3, s63, 81920
  buffer_load_dwordx4 v[96:99], v4, s[40:43], s3 offen sc1
  s_add_u32 s3, s63, 82944
  buffer_load_dwordx4 v[100:103], v4, s[40:43], s3 offen sc1
  s_add_u32 s3, s63, 83968
  buffer_load_dwordx4 v[104:107], v4, s[40:43], s3 offen sc1
  s_add_u32 s3, s63, 84992
  buffer_load_dwordx4 v[108:111], v4, s[40:43], s3 offen sc1
  s_add_u32 s3, s63, 86016
  buffer_load_dwordx4 v[112:115], v4, s[40:43], s3 offen sc1
  s_add_u32 s3, s63, 122880
  buffer_load_dwordx4 v[116:119], v4, s[40:43], s3 offen sc1
  s_add_u32 s3, s63, 123904
  buffer_load_dwordx4 v[120:123], v4, s[40:43], s3 offen sc1
  s_add_u32 s3, s63, 124928
  buffer_load_dwordx4 v[124:127], v4, s[40:43], s3 offen sc1
  s_add_u32 s3, s63, 125952
  buffer_load_dwordx4 v[128:131], v4, s[40:43], s3 offen sc1
  s_add_u32 s3, s63, 126976
  buffer_load_dwordx4 v[132:135], v4, s[40:43], s3 offen sc1
  s_add_u32 s3, s63, 163840
  buffer_load_dwordx4 v[136:139], v4, s[40:43], s3 offen sc1
  s_add_u32 s3, s63, 164864
  buffer_load_dwordx4 v[140:143], v4, s[40:43], s3 offen sc1
  s_add_u32 s3, s63, 165888
  buffer_load_dwordx4 v[144:147], v4, s[40:43], s3 offen sc1
  s_add_u32 s3, s63, 166912
  buffer_load_dwordx4 v[148:151], v4, s[40:43], s3 offen sc1
  s_add_u32 s3, s63, 167936
  buffer_load_dwordx4 v[152:155], v4, s[40:43], s3 offen sc1
  s_add_u32 s3, s63, 204800
  buffer_load_dwordx4 v[156:159], v4, s[40:43], s3 offen sc1
  s_add_u32 s3, s63, 205824
  buffer_load_dwordx4 v[160:163], v4, s[40:43], s3 offen sc1
  s_add_u32 s3, s63, 206848
  buffer_load_dwordx4 v[164:167], v4, s[40:43], s3 offen sc1
  s_add_u32 s3, s63, 207872
  buffer_load_dwordx4 v[168:171], v4, s[40:43], s3 offen sc1
  s_add_u32 s3, s63, 208896
  buffer_load_dwordx4 v[172:175], v4, s[40:43], s3 offen sc1
  s_add_u32 s3, s76, 0
  buffer_load_dwordx4 v[176:179], v4, s[40:43], s3 offen sc1
  s_add_u32 s3, s76, 1024
  buffer_load_dwordx4 v[180:183], v4, s[40:43], s3 offen sc1
  s_add_u32 s3, s76, 2048
  buffer_load_dwordx4 v[184:187], v4, s[40:43], s3 offen sc1
  s_add_u32 s3, s76, 3072
  buffer_load_dwordx4 v[188:191], v4, s[40:43], s3 offen sc1
  s_add_u32 s3, s76, 4096
  buffer_load_dwordx4 v[192:195], v4, s[40:43], s3 offen sc1
  s_add_u32 s3, s63, 40960
  buffer_load_dwordx4 v[216:219], v4, s[40:43], s3 offen sc1
  s_add_u32 s3, s63, 41984
  buffer_load_dwordx4 v[220:223], v4, s[40:43], s3 offen sc1
  s_add_u32 s3, s63, 43008
  buffer_load_dwordx4 v[224:227], v4, s[40:43], s3 offen sc1
  s_add_u32 s3, s63, 44032
  buffer_load_dwordx4 v[228:231], v4, s[40:43], s3 offen sc1
  s_add_u32 s3, s63, 45056
  buffer_load_dwordx4 v[232:235], v4, s[40:43], s3 offen sc1
  v_lshrrev_b32 v1, 2, v0
  v_mul_u32_u24 v1, 4224, v1
  v_and_b32 v2, 3, v0
  v_lshl_add_u32 v1, v2, 4, v1
  s_lshl_b32 s55, s86, 4
  s_add_u32 s55, s55, s87
  s_mul_i32 s55, s55, 4224
  s_lshl_b32 s56, s62, 7
  s_lshl_b32 s57, s90, 6
  s_add_u32 s56, s56, s57
  s_add_u32 s56, s56, 7340032
  s_cmp_ge_u32 s36, 5
  s_cselect_b32 s57, 2048, 0
  s_add_u32 s55, s55, s56
  s_add_u32 s55, s55, s57
  s_lshl_b32 s57, s36, 10
  s_add_u32 m0, s57, 16384
  s_nop 0
  buffer_load_dwordx4 v1, s[40:43], s55 offen sc1 lds
  s_add_u32 s55, s36, 3
  s_lshl_b32 s55, s55, 4
  s_add_u32 s55, s55, s87
  s_mul_i32 s55, s55, 4224
  s_add_u32 s55, s55, s56
  s_add_u32 s55, s55, 2048
  s_add_u32 m0, s57, 24576
  s_cmp_lt_u32 s36, 2
  s_cselect_b64 exec, -1, 0
  buffer_load_dwordx4 v1, s[40:43], s55 offen sc1 lds
  s_mov_b64 exec, -1
  s_cmp_lg_u32 s36, 0
  s_cbranch_scc1 L_ow_108
  v_mov_b32 v3, 0
  s_mov_b64 exec, 0x1
  global_atomic_add v3, v65, v3, s[34:35] offset:0 sc0 sc1
  s_mov_b64 exec, -1
  s_waitcnt vmcnt(0)
  v_cmp_gt_u32 vcc, 27, v3
  s_nop 0
  s_and_b32 vcc_lo, vcc_lo, 0x1
  s_cbranch_scc0 L_polld_110
L_poll_109:
  s_sleep 8
  v_mov_b32 v3, 0
  s_mov_b64 exec, 0x1
  global_atomic_add v3, v65, v3, s[34:35] offset:0 sc0 sc1
  s_mov_b64 exec, -1
  s_waitcnt vmcnt(0)
  v_cmp_gt_u32 vcc, 27, v3
  s_nop 0
  s_and_b32 vcc_lo, vcc_lo, 0x1
  s_cbranch_scc0 L_polld_110
  s_add_u32 s79, s79, 1
  s_cmp_lt_u32 s79, 400000
  s_cbranch_scc1 L_poll_109
L_polld_110:
L_ow_108:
  s_waitcnt vmcnt(0)
  s_barrier
  ds_read_b64_tr_b16 v[92:93], v70 offset:0
  ds_read_b64_tr_b16 v[94:95], v71 offset:0
  ds_read_b64_tr_b16 v[90:91], v70 offset:5120
  ds_read_b64_tr_b16 v[6:7], v71 offset:5120
  s_add_u32 s3, s83, 0
  buffer_load_dwordx4 v[16:19], v64, s[40:43], s3 offen offset:0 sc1
  buffer_load_dwordx4 v[20:23], v64, s[40:43], s3 offen offset:256 sc1
  s_add_u32 s3, s83, 16384
  buffer_load_dwordx4 v[24:27], v64, s[40:43], s3 offen offset:0 sc1
  buffer_load_dwordx4 v[28:31], v64, s[40:43], s3 offen offset:256 sc1
  global_load_dword v79, v72, s[34:35] sc1
  s_add_u32 s3, s83, 32768
  buffer_load_dwordx4 v[236:239], v64, s[40:43], s3 offen offset:0 sc1
  buffer_load_dwordx4 v[240:243], v64, s[40:43], s3 offen offset:256 sc1
  s_add_u32 s3, s83, 49152
  buffer_load_dwordx4 v[244:247], v64, s[40:43], s3 offen offset:0 sc1
  buffer_load_dwordx4 v[248:251], v64, s[40:43], s3 offen offset:256 sc1
  s_branch L_g2
L_end:
  s_endpgm
.section .rodata,"a"
.p2align 6
.amdhsa_kernel adaLN_cond__ssm_conv_s4d__geglu_ffn__prompt_kernel
  .amdhsa_next_free_vgpr 256
  .amdhsa_next_free_sgpr 102
  .amdhsa_accum_offset 256
  .amdhsa_group_segment_fixed_size 0
  .amdhsa_kernarg_size 128
  .amdhsa_user_sgpr_count 2
  .amdhsa_user_sgpr_kernarg_segment_ptr 1
  .amdhsa_system_sgpr_workgroup_id_x 1
.end_amdhsa_kernel
```
